```python
import torch

def _softmax(x, axis=-1):
    return torch.softmax(x, dim=axis)
def _gelu(x):
    return torch.nn.functional.gelu(x, approximate="tanh")
def _silu(x):
    return torch.nn.functional.silu(x)
def _sigmoid(x):
    return torch.sigmoid(x)
def _layernorm(x, axis=-1, eps=1e-5):
    m = x.mean(dim=axis, keepdim=True)
    v = x.var(dim=axis, keepdim=True, unbiased=False)
    return (x - m) / torch.sqrt(v + eps)
def _scatter_add(tgt, idx, src, axis=0):
    return tgt.clone().index_add_(axis, idx, src)
def _segment_sum(src, seg, n):
    out = torch.zeros((n,) + src.shape[1:], dtype=src.dtype)
    return out.index_add_(0, seg, src)
def _pad(x, pw):
    flat = tuple(v for pair in reversed(pw) for v in pair)
    return torch.nn.functional.pad(x, flat)

kernel_name = 'recurrent_scan__mha_block__moe_arch_mod__prompt'

def setup_inputs():

    _w = (lambda a: (lambda t: t.to(torch.bfloat16) if t.is_floating_point() else t)(torch.as_tensor(a)))
    def _A_setup():
        B, S, D, H = 1, 2048, 640, 32
        return {
            "x": _w((lambda *s: torch.randn(*s, dtype=torch.bfloat16) * 0.05)(B, S, D)),
            "wqkv": _w((lambda *s: torch.randn(*s, dtype=torch.bfloat16) * 0.05)(D, 3 * D)),
            "wo": _w((lambda *s: torch.randn(*s, dtype=torch.bfloat16) * 0.05)(D, D)),
        }
    _A_in = _A_setup()

    def _B_setup():
        B, S, D, F, C = 1, 2048, 640, 1536, 8
        return {
            "x": _w((lambda *s: torch.randn(*s, dtype=torch.bfloat16) * 0.05)(B, S, D)),
            "w_r": _w((lambda *s: torch.randn(*s, dtype=torch.bfloat16) * 0.05)(D)),
            "w_gate": _w((lambda *s: torch.randn(*s, dtype=torch.bfloat16) * 0.05)(D, F)),
            "w_up": _w((lambda *s: torch.randn(*s, dtype=torch.bfloat16) * 0.05)(D, F)),
            "w_down": _w((lambda *s: torch.randn(*s, dtype=torch.bfloat16) * 0.05)(F, D)),
        }
    _B_in = _B_setup()

    return {
        "A_x": _A_in["x"],
        "A_wqkv": _A_in["wqkv"],
        "A_wo": _A_in["wo"],
        "B_x": _B_in["x"],
        "B_w_r": _B_in["w_r"],
        "B_w_gate": _B_in["w_gate"],
        "B_w_up": _B_in["w_up"],
        "B_w_down": _B_in["w_down"],
    }

def reference(A_x, A_wqkv, A_wo, B_x, B_w_r, B_w_gate, B_w_up, B_w_down):
    def _A_ref(x, wqkv, wo):
        B, S, D = x.shape
        H = 32
        Dh = D // H
        qkv = (lambda x, *d: x.permute(*d))((x @ wqkv).reshape(B, S, 3, H, Dh), 2, 0, 3, 1, 4)
        q, k, v = qkv[0], qkv[1], qkv[2]
        scores = torch.einsum("bhqd,bhkd->bhqk", q, k) * (Dh ** -0.5)
        p = _softmax(scores, axis=-1)
        o = torch.einsum("bhqk,bhkd->bhqd", p, v)
        return (lambda x, *d: x.permute(*d))(o, 0, 2, 1, 3).reshape(B, S, D) @ wo

    def _B_ref(x, w_r, w_gate, w_up, w_down):
        B, S, D = x.shape
        C = 8
        r = x @ w_r
        idx = torch.argsort(-r, axis=-1)[:, :C]
        idx_e = (lambda x, n, axis: torch.repeat_interleave(x, n, dim=axis))(idx.reshape(B, C, 1), D, axis=2)
        x_sel = (lambda x, i, axis: torch.take_along_dim(x, i, dim=axis))(x, idx_e, axis=1)
        g = _silu(x_sel @ w_gate)
        u = x_sel @ w_up
        y = (g * u) @ w_down
        r_sel = _sigmoid((lambda x, i, axis: torch.take_along_dim(x, i, dim=axis))(r, idx, axis=1))
        y = y * r_sel.reshape(B, C, 1)
        b_off = (torch.arange(B) * S).reshape(B, 1)
        flat_idx = (idx + b_off).reshape(B * C)
        zero = (x * 0.0).reshape(B * S, D)
        upd = _scatter_add(zero, flat_idx, y.reshape(B * C, D), axis=0)
        return x + upd.reshape(B, S, D)

    x = A_x
    xn = _layernorm(x, axis=-1)
    s = _A_ref(xn, A_wqkv, A_wo)
    g = _silu(_B_ref(xn, B_w_r, B_w_gate, B_w_up, B_w_down))
    return x + s * g
```

```asm
; @launch kernel=qkv_kernel grid=(256,1,1) block=(512,1,1) lds=133120
; @launch kernel=attn_kernel grid=(352,1,1) block=(512,1,1) lds=81920
.amdgcn_target "amdgcn-amd-amdhsa--gfx950"
.text
.globl qkv_kernel
.p2align 8
.type qkv_kernel,@function
qkv_kernel:
    s_cmp_ge_u32 s2, 256
    s_cbranch_scc1 k1_exit
    s_load_dwordx4 s[4:7], s[0:1], 0
    s_load_dwordx4 s[8:11], s[0:1], 72
    s_getpc_b64 s[40:41]
    v_lshlrev_b32 v3, 7, v0
    v_cmp_gt_u32 vcc, attn_kernel-qkv_kernel-1024, v3
    s_and_saveexec_b64 s[42:43], vcc
    s_cbranch_execz k1_ncp
    global_load_dword v31, v3, s[40:41]
k1_ncp:
    s_mov_b64 exec, s[42:43]
    v_lshrrev_b32 v2, 6, v0
    v_and_b32 v1, 63, v0
    s_and_b32 s28, s2, 7
    v_readfirstlane_b32 s24, v2
    s_lshr_b32 s29, s2, 3
    s_lshr_b32 s30, s28, 1
    s_and_b32 s28, s28, 1
    s_lshl_b32 s30, s30, 2
    s_cmp_lt_u32 s29, 2
    s_cbranch_scc0 k1_gemm
    s_lshl_b32 s28, s28, 1
    s_add_u32 s25, s30, s28
    s_add_u32 s25, s25, s29
    s_waitcnt lgkmcnt(0)
    s_branch k1_router
k1_exit:
    s_endpgm
k1_gemm:
    s_mul_i32 s28, s28, 30
    s_add_u32 s28, s28, s29
    s_sub_u32 s28, s28, 2
    s_lshr_b32 s26, s28, 2
    s_and_b32 s28, s28, 3
    s_add_u32 s25, s30, s28
    s_cmp_ge_u32 s24, 4
    s_cbranch_scc0 k1_comp
k1_loader:
    s_load_dwordx2 s[48:49], s[0:1], 16
    s_sub_u32 s39, s24, 4
    s_sub_u32 s36, s2, 16
    v_lshrrev_b32 v5, 3, v1
    v_mul_u32_u24 v5, 1280, v5
    v_lshrrev_b32 v6, 4, v1
    v_and_b32 v7, 7, v1
    v_xor_b32 v7, v7, v6
    v_lshl_add_u32 v2, v7, 4, v5
    v_xor_b32 v3, 64, v2
    v_mul_u32_u24 v5, 3840, v6
    v_lshlrev_b32 v7, 2, v6
    v_and_b32 v8, 15, v1
    v_xor_b32 v7, v7, v8
    v_lshl_add_u32 v4, v7, 4, v5
    s_lshl_b32 s34, s25, 2
    s_add_u32 s34, s34, s39
    s_mul_i32 s34, s34, 40960
    s_mul_i32 s35, s39, 61440
    s_lshl_b32 s31, s26, 8
    s_add_u32 s35, s35, s31
    s_and_b32 s32, s25, 3
    s_mul_i32 s32, s32, 3
    s_add_u32 s32, s32, s26
    s_sub_u32 s31, s32, 10
    s_cselect_b32 s32, s32, s31
    s_sub_u32 s31, s32, 10
    s_cselect_b32 s32, s32, s31
    s_and_b32 s32, s25, 3
    s_add_u32 s32, s32, s26
    s_mul_i32 s31, s32, 86
    s_lshr_b32 s31, s31, 8
    s_mul_i32 s31, s31, 3
    s_sub_u32 s32, s32, s31
    s_lshl_b32 s32, s32, 2
    s_lshr_b32 s32, 0x730, s32
    s_and_b32 s32, s32, 15
    s_lshl_b32 s28, s32, 7
    s_add_u32 s28, s28, s34
    s_mul_i32 s29, s32, 245760
    s_add_u32 s29, s29, s35
    s_lshl_b32 s30, s39, 12
    s_mov_b32 s27, 0
    s_waitcnt lgkmcnt(0)
    s_mov_b32 s12, s4
    s_mov_b32 s13, s5
    s_mov_b32 s14, 2621440
    s_mov_b32 s15, 0x20000
    s_mov_b32 s16, s6
    s_mov_b32 s17, s7
    s_mov_b32 s18, 2457600
    s_mov_b32 s19, 0x20000
k1l_loop:
    s_mov_b32 m0, s30
    s_add_u32 s31, s28, 10240
    buffer_load_dwordx4 v2, s[12:15], s28 offen lds
    s_addk_i32 m0, 0x4000
    s_add_u32 s33, s29, 15360
    buffer_load_dwordx4 v4, s[16:19], s29 offen lds
    s_addk_i32 m0, -15360
    s_addk_i32 s28, 128
    buffer_load_dwordx4 v3, s[12:15], s31 offen lds
    s_addk_i32 m0, 0x4000
    s_addk_i32 s31, 10240
    buffer_load_dwordx4 v4, s[16:19], s33 offen lds
    s_addk_i32 m0, -15360
    s_addk_i32 s33, 15360
    buffer_load_dwordx4 v2, s[12:15], s31 offen lds
    s_addk_i32 m0, 0x4000
    s_addk_i32 s31, 10240
    buffer_load_dwordx4 v4, s[16:19], s33 offen lds
    s_addk_i32 m0, -15360
    s_addk_i32 s33, 15360
    buffer_load_dwordx4 v3, s[12:15], s31 offen lds
    s_addk_i32 m0, 0x4000
    s_add_u32 s29, s29, 245760
    buffer_load_dwordx4 v4, s[16:19], s33 offen lds
    s_add_u32 s30, s30, 0x8000
    s_and_b32 s30, s30, 131071
    s_add_u32 s32, s32, 1
    s_cmp_eq_u32 s32, 10
    s_cselect_b32 s28, s34, s28
    s_cselect_b32 s29, s35, s29
    s_add_u32 s27, s27, 1
    s_cmp_eq_u32 s27, 1
    s_cbranch_scc1 k1l_loop
    s_cmp_eq_u32 s27, 10
    s_cbranch_scc1 k1l_tail
    s_waitcnt vmcnt(8)
    s_barrier
    s_cmp_lg_u32 s27, 6
    s_cbranch_scc1 k1l_loop
    s_min_u32 s31, s36, 159
    s_lshl_b32 s31, s31, 2
    s_add_u32 s31, s31, s39
    s_mul_i32 s31, s31, 1280
    s_add_u32 s40, s48, s31
    s_addc_u32 s41, s49, 0
    s_load_dword s52, s[40:41], 0
    s_load_dword s53, s[40:41], 128
    s_load_dword s54, s[40:41], 256
    s_load_dword s55, s[40:41], 384
    s_load_dword s56, s[40:41], 512
    s_load_dword s57, s[40:41], 640
    s_load_dword s58, s[40:41], 768
    s_load_dword s59, s[40:41], 896
    s_load_dword s60, s[40:41], 1024
    s_load_dword s61, s[40:41], 1152
    s_branch k1l_loop
k1l_tail:
    s_cmp_ge_u32 s39, 2
    s_cbranch_scc0 k1l_st
    s_mov_b32 s20, s10
    s_mov_b32 s21, s11
    s_mov_b32 s22, 11634688
    s_mov_b32 s23, 0x20000
    v_and_b32 v5, 127, v0
    s_cmp_ge_u32 s36, 160
    s_cbranch_scc1 k1l_hk2
    s_mov_b32 s50, 819200
    s_mov_b32 s51, 0x20000
    s_mul_i32 s31, s36, 5120
    v_lshlrev_b32 v6, 4, v5
    buffer_load_dwordx4 v[16:19], v6, s[48:51], s31 offen
    buffer_load_dwordx4 v[20:23], v6, s[48:51], s31 offen offset:2048
    s_addk_i32 s31, 4096
    buffer_load_dwordx4 v[24:27], v6, s[48:51], s31 offen
    v_add_u32 v6, 0, v5
    v_mul_u32_u24 v7, 6554, v6
    v_lshrrev_b32 v7, 16, v7
    v_mul_u32_u24 v8, 10, v7
    v_sub_u32 v8, v6, v8
    v_lshlrev_b32 v8, 4, v8
    v_lshrrev_b32 v9, 3, v7
    v_mul_u32_u24 v9, 160, v9
    v_and_b32 v7, 7, v7
    v_mul_u32_u24 v7, 0x19000, v7
    v_add3_u32 v10, v8, v9, v7
    v_add_u32 v6, 128, v5
    v_mul_u32_u24 v7, 6554, v6
    v_lshrrev_b32 v7, 16, v7
    v_mul_u32_u24 v8, 10, v7
    v_sub_u32 v8, v6, v8
    v_lshlrev_b32 v8, 4, v8
    v_lshrrev_b32 v9, 3, v7
    v_mul_u32_u24 v9, 160, v9
    v_and_b32 v7, 7, v7
    v_mul_u32_u24 v7, 0x19000, v7
    v_add3_u32 v11, v8, v9, v7
    v_add_u32 v6, 256, v5
    v_mul_u32_u24 v7, 6554, v6
    v_lshrrev_b32 v7, 16, v7
    v_mul_u32_u24 v8, 10, v7
    v_sub_u32 v8, v6, v8
    v_lshlrev_b32 v8, 4, v8
    v_lshrrev_b32 v9, 3, v7
    v_mul_u32_u24 v9, 160, v9
    v_and_b32 v7, 7, v7
    v_mul_u32_u24 v7, 0x19000, v7
    v_add3_u32 v12, v8, v9, v7
    s_mul_i32 s33, s36, 205
    s_lshr_b32 s33, s33, 10
    s_mul_i32 s31, s33, 5
    s_sub_u32 s31, s36, s31
    s_lshl_b32 s37, s33, 2
    s_add_u32 s37, s37, s31
    s_add_u32 s33, s33, 128
    s_cmp_eq_u32 s31, 4
    s_cselect_b32 s37, s33, s37
    s_lshr_b32 s31, s37, 3
    s_mul_i32 s31, s31, 5120
    s_bfe_u32 s33, s37, 0x20001
    s_mul_i32 s33, s33, 640
    s_add_u32 s31, s31, s33
    s_and_b32 s33, s37, 1
    s_mul_i32 s33, s33, 2560
    s_add_u32 s31, s31, s33
    s_add_u32 s31, s31, 10815488
    s_waitcnt vmcnt(11)
    s_barrier
    s_waitcnt vmcnt(3)
    s_barrier
    s_waitcnt vmcnt(0)
    buffer_store_dwordx4 v[16:19], v10, s[20:23], s31 offen
    buffer_store_dwordx4 v[20:23], v11, s[20:23], s31 offen
    s_cmp_eq_u32 s39, 3
    s_cbranch_scc1 k1_exit
    buffer_store_dwordx4 v[24:27], v12, s[20:23], s31 offen
    s_endpgm
k1l_hk2:
    s_waitcnt vmcnt(8)
    s_barrier
    s_waitcnt vmcnt(0)
    s_barrier
    s_cmp_ge_u32 s36, 232
    s_cbranch_scc1 k1l_hk3
    s_cmp_ge_u32 s36, 208
    s_cbranch_scc1 k1_exit
    v_mov_b32 v16, 0
    v_mov_b32 v17, 0
    v_mov_b32 v18, 0
    v_mov_b32 v19, 0
    v_lshlrev_b32 v6, 4, v5
    s_lshl_b32 s31, s36, 11
    s_add_u32 s31, s31, 10389504
    buffer_store_dwordx4 v[16:19], v6, s[20:23], s31 offen
    s_endpgm
k1l_hk3:
    s_getpc_b64 s[44:45]
k1l_pc:
    s_add_u32 s44, s44, attn_kernel-k1l_pc
    s_addc_u32 s45, s45, 0
    s_mov_b32 s46, code_end-attn_kernel
    s_mov_b32 s47, 0x20000
    v_lshlrev_b32 v6, 7, v5
    buffer_load_dword v7, v6, s[44:47], 0 offen
    s_endpgm
k1l_st:
    s_lshl_b32 s31, s25, 2
    v_mov_b32 v5, s31
    global_load_dword v8, v5, s[8:9] sc1
    s_waitcnt vmcnt(9)
    s_barrier
    s_mov_b32 s20, s10
    s_mov_b32 s21, s11
    s_mov_b32 s22, 11634688
    s_mov_b32 s23, 0x20000
    s_lshl_b32 s33, s39, 6
    v_add_u32 v6, s33, v1
    v_lshlrev_b32 v7, 2, v6
    v_add_u32 v6, 131072, v7
    s_lshl_b32 s33, s25, 9
    s_add_u32 s33, s33, 10485760
    s_cmp_lt_u32 s26, 5
    s_cselect_b32 s37, 0x3ea52b5c, 1.0
    s_mov_b32 s27, 0
    s_waitcnt vmcnt(1)
    s_barrier
k1l_poll:
    s_waitcnt vmcnt(0)
    v_readfirstlane_b32 s31, v8
    s_add_u32 s27, s27, 1
    s_cmp_lg_u32 s31, 0
    s_cbranch_scc1 k1l_go
    s_cmp_ge_u32 s27, 0x20000
    s_cbranch_scc1 k1l_go
    s_sleep 2
    global_load_dword v8, v5, s[8:9] sc1
    s_branch k1l_poll
k1l_go:
    buffer_load_dword v10, v7, s[20:23], s33 offen sc1
    s_waitcnt vmcnt(0)
    v_and_b32 v11, 0xffff0000, v10
    v_rcp_f32 v11, v11
    v_and_b32 v10, 0xffff, v10
    v_lshl_or_b32 v10, v10, 16, v10
    v_mul_f32 v11, s37, v11
    ds_write_b32 v6, v10
    ds_write_b32 v6, v11 offset:512
    s_waitcnt lgkmcnt(0)
    s_barrier
    s_endpgm
k1_comp:
    s_mov_b32 s27, 0
    s_mov_b32 s35, 4294868992
    s_mov_b32 s36, 0x8000
    s_and_b32 s38, s24, 1
    s_lshl_b32 s38, s38, 1
    s_lshr_b32 s31, s24, 1
    s_add_u32 s38, s38, s31
    s_lshl_b32 s30, s31, 13
    v_and_b32 v18, 31, v1
    v_lshlrev_b32 v18, 7, v18
    v_lshrrev_b32 v19, 5, v1
    v_bfe_u32 v20, v1, 1, 3
    v_xor_b32 v20, v20, v19
    v_lshl_add_u32 v18, v20, 4, v18
    v_add_u32 v5, s30, v18
    v_xor_b32 v6, 32, v5
    v_xor_b32 v7, 64, v5
    v_xor_b32 v8, 96, v5
    v_bfe_u32 v20, v1, 2, 2
    v_lshl_add_u32 v21, v19, 3, v20
    v_lshlrev_b32 v21, 8, v21
    v_xor_b32 v20, s38, v20
    v_lshl_add_u32 v21, v20, 6, v21
    v_bfe_u32 v20, v1, 4, 1
    v_lshl_add_u32 v21, v20, 5, v21
    v_and_b32 v20, 3, v1
    s_cmp_ge_u32 s26, 10
    s_cselect_b32 s31, 0xe4, 0
    s_cselect_b32 s33, 0, 0xd8
    s_or_b32 s31, s31, s33
    v_lshlrev_b32 v20, 1, v20
    v_lshrrev_b32 v20, v20, s31
    v_and_b32 v20, 3, v20
    v_lshl_add_u32 v21, v20, 3, v21
    v_add_u32 v13, 0x4000, v21
    v_xor_b32 v14, 64, v13
    s_mov_b32 s40, 0x00100001
    s_mov_b32 s41, 0x00100001
    v_mov_b32 v24, 0x3f803f80
    v_mov_b32 v16, 0
    v_cndmask_b32 v20, 0, v24, s[40:41]
    v_mov_b32 v17, 0
    v_cndmask_b32 v21, 0, v24, s[40:41]
    v_mov_b32 v18, 0
    v_cndmask_b32 v22, 0, v24, s[40:41]
    v_mov_b32 v19, 0
    v_cndmask_b32 v23, 0, v24, s[40:41]
    v_mov_b32 v96, 0
    v_mov_b32 v97, 0
    v_mov_b32 v98, 0
    v_mov_b32 v99, 0
    v_mov_b32 v100, 0
    v_mov_b32 v101, 0
    v_mov_b32 v102, 0
    v_mov_b32 v103, 0
    v_mov_b32 v104, 0
    v_mov_b32 v105, 0
    v_mov_b32 v106, 0
    v_mov_b32 v107, 0
    v_mov_b32 v108, 0
    v_mov_b32 v109, 0
    v_mov_b32 v110, 0
    v_mov_b32 v111, 0
    v_mov_b32 v112, 0
    v_mov_b32 v113, 0
    v_mov_b32 v114, 0
    v_mov_b32 v115, 0
    v_mov_b32 v116, 0
    v_mov_b32 v117, 0
    v_mov_b32 v118, 0
    v_mov_b32 v119, 0
    v_mov_b32 v120, 0
    v_mov_b32 v121, 0
    v_mov_b32 v122, 0
    v_mov_b32 v123, 0
    v_mov_b32 v124, 0
    v_mov_b32 v125, 0
    v_mov_b32 v126, 0
    v_mov_b32 v127, 0
    v_mov_b32 v128, 0
    v_mov_b32 v129, 0
    v_mov_b32 v130, 0
    v_mov_b32 v131, 0
    v_mov_b32 v132, 0
    v_mov_b32 v133, 0
    v_mov_b32 v134, 0
    v_mov_b32 v135, 0
    v_mov_b32 v136, 0
    v_mov_b32 v137, 0
    v_mov_b32 v138, 0
    v_mov_b32 v139, 0
    v_mov_b32 v140, 0
    v_mov_b32 v141, 0
    v_mov_b32 v142, 0
    v_mov_b32 v143, 0
    v_mov_b32 v144, 0
    v_mov_b32 v145, 0
    v_mov_b32 v146, 0
    v_mov_b32 v147, 0
    v_mov_b32 v148, 0
    v_mov_b32 v149, 0
    v_mov_b32 v150, 0
    v_mov_b32 v151, 0
    v_mov_b32 v152, 0
    v_mov_b32 v153, 0
    v_mov_b32 v154, 0
    v_mov_b32 v155, 0
    v_mov_b32 v156, 0
    v_mov_b32 v157, 0
    v_mov_b32 v158, 0
    v_mov_b32 v159, 0
    s_waitcnt lgkmcnt(0)
    s_mov_b32 s20, s10
    s_mov_b32 s21, s11
    s_mov_b32 s22, 11634688
    s_mov_b32 s23, 0x20000
    s_cmp_ge_u32 s26, 10
    s_cbranch_scc1 k1_vbody
    s_barrier
    ds_read_b128 v[32:35], v5
    ds_read_b64_tr_b16 v[40:41], v13 offset:0
    ds_read_b64_tr_b16 v[42:43], v13 offset:1024
    ds_read_b64_tr_b16 v[44:45], v14 offset:0
    ds_read_b64_tr_b16 v[46:47], v14 offset:1024
    ds_read_b128 v[36:39], v5 offset:4096
    ds_read_b128 v[48:51], v6
    ds_read_b64_tr_b16 v[56:57], v13 offset:4096
    ds_read_b64_tr_b16 v[58:59], v13 offset:5120
    ds_read_b64_tr_b16 v[60:61], v14 offset:4096
    ds_read_b64_tr_b16 v[62:63], v14 offset:5120
    ds_read_b128 v[52:55], v6 offset:4096
k1q_loop:
    s_and_b32 s32, s27, 3
    s_cmp_eq_u32 s32, 3
    s_cselect_b32 s33, s35, s36
    s_waitcnt lgkmcnt(6)
    v_mfma_f32_32x32x16_bf16 v[96:111], v[40:43], v[32:35], v[96:111]
    ds_read_b128 v[64:67], v7
    ds_read_b64_tr_b16 v[72:73], v13 offset:8192
    v_mfma_f32_32x32x16_bf16 v[112:127], v[44:47], v[32:35], v[112:127]
    ds_read_b64_tr_b16 v[74:75], v13 offset:9216
    ds_read_b64_tr_b16 v[76:77], v14 offset:8192
    v_mfma_f32_32x32x16_bf16 v[128:143], v[40:43], v[36:39], v[128:143]
    ds_read_b64_tr_b16 v[78:79], v14 offset:9216
    v_add_u32 v5, s33, v5
    v_mfma_f32_32x32x16_bf16 v[144:159], v[44:47], v[36:39], v[144:159]
    ds_read_b128 v[68:71], v7 offset:4096
    v_add_u32 v6, s33, v6
    v_mfma_f32_16x16x32_bf16 v[16:19], v[20:23], v[40:43], v[16:19]
    s_waitcnt lgkmcnt(6)
    v_mfma_f32_32x32x16_bf16 v[96:111], v[56:59], v[48:51], v[96:111]
    ds_read_b128 v[80:83], v8
    ds_read_b64_tr_b16 v[88:89], v13 offset:12288
    v_mfma_f32_32x32x16_bf16 v[112:127], v[60:63], v[48:51], v[112:127]
    ds_read_b64_tr_b16 v[90:91], v13 offset:13312
    ds_read_b64_tr_b16 v[92:93], v14 offset:12288
    v_mfma_f32_32x32x16_bf16 v[128:143], v[56:59], v[52:55], v[128:143]
    ds_read_b64_tr_b16 v[94:95], v14 offset:13312
    v_add_u32 v7, s33, v7
    v_add_u32 v13, s33, v13
    v_mfma_f32_32x32x16_bf16 v[144:159], v[60:63], v[52:55], v[144:159]
    ds_read_b128 v[84:87], v8 offset:4096
    v_add_u32 v14, s33, v14
    v_add_u32 v8, s33, v8
    v_mfma_f32_16x16x32_bf16 v[16:19], v[20:23], v[56:59], v[16:19]
    s_add_u32 s27, s27, 1
    s_cmp_eq_u32 s27, 10
    s_waitcnt lgkmcnt(6)
    s_cbranch_scc1 k1q_nb
    s_barrier
k1q_nb:
    v_mfma_f32_32x32x16_bf16 v[96:111], v[72:75], v[64:67], v[96:111]
    ds_read_b128 v[32:35], v5
    ds_read_b64_tr_b16 v[40:41], v13 offset:0
    v_mfma_f32_32x32x16_bf16 v[112:127], v[76:79], v[64:67], v[112:127]
    ds_read_b64_tr_b16 v[42:43], v13 offset:1024
    ds_read_b64_tr_b16 v[44:45], v14 offset:0
    v_mfma_f32_32x32x16_bf16 v[128:143], v[72:75], v[68:71], v[128:143]
    ds_read_b64_tr_b16 v[46:47], v14 offset:1024
    v_mfma_f32_32x32x16_bf16 v[144:159], v[76:79], v[68:71], v[144:159]
    ds_read_b128 v[36:39], v5 offset:4096
    v_mfma_f32_16x16x32_bf16 v[16:19], v[20:23], v[72:75], v[16:19]
    s_waitcnt lgkmcnt(6)
    v_mfma_f32_32x32x16_bf16 v[96:111], v[88:91], v[80:83], v[96:111]
    ds_read_b128 v[48:51], v6
    ds_read_b64_tr_b16 v[56:57], v13 offset:4096
    v_mfma_f32_32x32x16_bf16 v[112:127], v[92:95], v[80:83], v[112:127]
    ds_read_b64_tr_b16 v[58:59], v13 offset:5120
    ds_read_b64_tr_b16 v[60:61], v14 offset:4096
    v_mfma_f32_32x32x16_bf16 v[128:143], v[88:91], v[84:87], v[128:143]
    ds_read_b64_tr_b16 v[62:63], v14 offset:5120
    v_mfma_f32_32x32x16_bf16 v[144:159], v[92:95], v[84:87], v[144:159]
    ds_read_b128 v[52:55], v6 offset:4096
    v_mfma_f32_16x16x32_bf16 v[16:19], v[20:23], v[88:91], v[16:19]
    s_cbranch_scc0 k1q_loop
    s_waitcnt vmcnt(0)
    v_and_b32 v24, 31, v1
    v_lshlrev_b32 v24, 2, v24
    s_lshr_b32 s31, s24, 1
    s_lshl_b32 s31, s31, 8
    s_add_u32 s31, s31, 131072
    v_add_u32 v9, s31, v24
    s_lshl_b32 s33, s38, 8
    s_add_u32 s33, s33, 132096
    v_lshl_add_u32 v10, v1, 2, s33
    v_cvt_pk_bf16_f32 v26, v16, v16
    v_mov_b32 v23, 0
    v_and_b32 v26, 0xffff0000, v26
    v_mov_b32 v25, 0
    v_sub_f32 v16, v16, v26
    v_mov_b32 v27, 0
    v_cvt_pk_bf16_f32 v26, -v26, -v16
    v_mov_b32 v29, 0
    ds_write_b32 v10, v26
    v_xor_b32 v10, 256, v10
    s_lshl_b32 s42, s25, 2
    s_and_b32 s43, s24, 2
    s_waitcnt lgkmcnt(0)
    s_barrier
    ds_read_b32 v22, v9
    ds_read_b32 v24, v9 offset:128
    ds_read_b32 v28, v10
    ds_read_b32 v30, v9 offset:512
    ds_read_b32 v20, v9 offset:640
    s_waitcnt lgkmcnt(2)
    v_mfma_f32_32x32x8_bf16 v[96:111], v[26:27], v[22:23], v[96:111]
    v_mfma_f32_32x32x8_bf16 v[128:143], v[26:27], v[24:25], v[128:143]
    v_mfma_f32_32x32x8_bf16 v[112:127], v[28:29], v[22:23], v[112:127]
    v_mfma_f32_32x32x8_bf16 v[144:159], v[28:29], v[24:25], v[144:159]
    v_lshlrev_b32 v18, 4, v1
    v_and_b32 v19, 32, v1
    v_add_u32 v19, v19, v1
    v_lshlrev_b32 v19, 3, v19
    s_add_u32 s42, s42, s43
    s_mul_i32 s42, s42, 122880
    s_add_u32 s43, s42, 122880
    s_lshl_b32 s44, s26, 2
    s_add_u32 s44, s44, s38
    s_xor_b32 s45, s44, 1
    s_waitcnt lgkmcnt(0)
    s_add_u32 s48, s44, 2
    s_mul_i32 s31, s48, 205
    s_lshr_b32 s31, s31, 10
    s_mul_i32 s31, s31, 5
    s_sub_u32 s48, s48, s31
    s_add_u32 s49, s45, 2
    s_mul_i32 s31, s49, 205
    s_lshr_b32 s31, s31, 10
    s_mul_i32 s31, s31, 5
    s_sub_u32 s49, s49, s31
    s_lshl_b32 s44, s44, 11
    s_lshl_b32 s45, s45, 11
    s_add_u32 s46, s42, s44
    v_pk_mul_f32 v[96:97], v[96:97], v[30:31] op_sel_hi:[1,0]
    v_pk_mul_f32 v[98:99], v[98:99], v[30:31] op_sel_hi:[1,0]
    v_pk_mul_f32 v[100:101], v[100:101], v[30:31] op_sel_hi:[1,0]
    v_pk_mul_f32 v[102:103], v[102:103], v[30:31] op_sel_hi:[1,0]
    v_pk_mul_f32 v[104:105], v[104:105], v[30:31] op_sel_hi:[1,0]
    v_pk_mul_f32 v[106:107], v[106:107], v[30:31] op_sel_hi:[1,0]
    v_pk_mul_f32 v[108:109], v[108:109], v[30:31] op_sel_hi:[1,0]
    v_pk_mul_f32 v[110:111], v[110:111], v[30:31] op_sel_hi:[1,0]
    v_cvt_pk_bf16_f32 v96, v96, v97
    v_cvt_pk_bf16_f32 v97, v98, v99
    v_cvt_pk_bf16_f32 v98, v100, v101
    v_cvt_pk_bf16_f32 v99, v102, v103
    v_cvt_pk_bf16_f32 v100, v104, v105
    v_cvt_pk_bf16_f32 v101, v106, v107
    v_cvt_pk_bf16_f32 v102, v108, v109
    v_cvt_pk_bf16_f32 v103, v110, v111
    s_cmp_lg_u32 s48, 0
    s_cselect_b32 exec_lo, -1, 0
    s_cmp_lg_u32 s48, 1
    s_cselect_b32 exec_hi, -1, 0
    buffer_store_dwordx4 v[96:99], v18, s[20:23], s46 offen offset:0 sc1
    s_not_b64 exec, exec
    s_cbranch_execz k1q_s000
    buffer_store_dwordx2 v[96:97], v19, s[20:23], s46 offen offset:0 sc1
    buffer_store_dwordx2 v[98:99], v19, s[20:23], s46 offen offset:256 sc1
k1q_s000:
    s_cmp_lg_u32 s48, 2
    s_cselect_b32 exec_lo, -1, 0
    s_cmp_lg_u32 s48, 3
    s_cselect_b32 exec_hi, -1, 0
    buffer_store_dwordx4 v[100:103], v18, s[20:23], s46 offen offset:1024 sc1
    s_not_b64 exec, exec
    s_cbranch_execz k1q_s001
    buffer_store_dwordx2 v[100:101], v19, s[20:23], s46 offen offset:1024 sc1
    buffer_store_dwordx2 v[102:103], v19, s[20:23], s46 offen offset:1280 sc1
k1q_s001:
    s_mov_b64 exec, -1
    s_add_u32 s46, s43, s44
    v_pk_mul_f32 v[128:129], v[128:129], v[20:21] op_sel_hi:[1,0]
    v_pk_mul_f32 v[130:131], v[130:131], v[20:21] op_sel_hi:[1,0]
    v_pk_mul_f32 v[132:133], v[132:133], v[20:21] op_sel_hi:[1,0]
    v_pk_mul_f32 v[134:135], v[134:135], v[20:21] op_sel_hi:[1,0]
    v_pk_mul_f32 v[136:137], v[136:137], v[20:21] op_sel_hi:[1,0]
    v_pk_mul_f32 v[138:139], v[138:139], v[20:21] op_sel_hi:[1,0]
    v_pk_mul_f32 v[140:141], v[140:141], v[20:21] op_sel_hi:[1,0]
    v_pk_mul_f32 v[142:143], v[142:143], v[20:21] op_sel_hi:[1,0]
    v_cvt_pk_bf16_f32 v128, v128, v129
    v_cvt_pk_bf16_f32 v129, v130, v131
    v_cvt_pk_bf16_f32 v130, v132, v133
    v_cvt_pk_bf16_f32 v131, v134, v135
    v_cvt_pk_bf16_f32 v132, v136, v137
    v_cvt_pk_bf16_f32 v133, v138, v139
    v_cvt_pk_bf16_f32 v134, v140, v141
    v_cvt_pk_bf16_f32 v135, v142, v143
    s_cmp_lg_u32 s48, 0
    s_cselect_b32 exec_lo, -1, 0
    s_cmp_lg_u32 s48, 1
    s_cselect_b32 exec_hi, -1, 0
    buffer_store_dwordx4 v[128:131], v18, s[20:23], s46 offen offset:0 sc1
    s_not_b64 exec, exec
    s_cbranch_execz k1q_s100
    buffer_store_dwordx2 v[128:129], v19, s[20:23], s46 offen offset:0 sc1
    buffer_store_dwordx2 v[130:131], v19, s[20:23], s46 offen offset:256 sc1
k1q_s100:
    s_cmp_lg_u32 s48, 2
    s_cselect_b32 exec_lo, -1, 0
    s_cmp_lg_u32 s48, 3
    s_cselect_b32 exec_hi, -1, 0
    buffer_store_dwordx4 v[132:135], v18, s[20:23], s46 offen offset:1024 sc1
    s_not_b64 exec, exec
    s_cbranch_execz k1q_s101
    buffer_store_dwordx2 v[132:133], v19, s[20:23], s46 offen offset:1024 sc1
    buffer_store_dwordx2 v[134:135], v19, s[20:23], s46 offen offset:1280 sc1
k1q_s101:
    s_mov_b64 exec, -1
    s_add_u32 s46, s42, s45
    v_pk_mul_f32 v[112:113], v[112:113], v[30:31] op_sel_hi:[1,0]
    v_pk_mul_f32 v[114:115], v[114:115], v[30:31] op_sel_hi:[1,0]
    v_pk_mul_f32 v[116:117], v[116:117], v[30:31] op_sel_hi:[1,0]
    v_pk_mul_f32 v[118:119], v[118:119], v[30:31] op_sel_hi:[1,0]
    v_pk_mul_f32 v[120:121], v[120:121], v[30:31] op_sel_hi:[1,0]
    v_pk_mul_f32 v[122:123], v[122:123], v[30:31] op_sel_hi:[1,0]
    v_pk_mul_f32 v[124:125], v[124:125], v[30:31] op_sel_hi:[1,0]
    v_pk_mul_f32 v[126:127], v[126:127], v[30:31] op_sel_hi:[1,0]
    v_cvt_pk_bf16_f32 v112, v112, v113
    v_cvt_pk_bf16_f32 v113, v114, v115
    v_cvt_pk_bf16_f32 v114, v116, v117
    v_cvt_pk_bf16_f32 v115, v118, v119
    v_cvt_pk_bf16_f32 v116, v120, v121
    v_cvt_pk_bf16_f32 v117, v122, v123
    v_cvt_pk_bf16_f32 v118, v124, v125
    v_cvt_pk_bf16_f32 v119, v126, v127
    s_cmp_lg_u32 s49, 0
    s_cselect_b32 exec_lo, -1, 0
    s_cmp_lg_u32 s49, 1
    s_cselect_b32 exec_hi, -1, 0
    buffer_store_dwordx4 v[112:115], v18, s[20:23], s46 offen offset:0 sc1
    s_not_b64 exec, exec
    s_cbranch_execz k1q_s010
    buffer_store_dwordx2 v[112:113], v19, s[20:23], s46 offen offset:0 sc1
    buffer_store_dwordx2 v[114:115], v19, s[20:23], s46 offen offset:256 sc1
k1q_s010:
    s_cmp_lg_u32 s49, 2
    s_cselect_b32 exec_lo, -1, 0
    s_cmp_lg_u32 s49, 3
    s_cselect_b32 exec_hi, -1, 0
    buffer_store_dwordx4 v[116:119], v18, s[20:23], s46 offen offset:1024 sc1
    s_not_b64 exec, exec
    s_cbranch_execz k1q_s011
    buffer_store_dwordx2 v[116:117], v19, s[20:23], s46 offen offset:1024 sc1
    buffer_store_dwordx2 v[118:119], v19, s[20:23], s46 offen offset:1280 sc1
k1q_s011:
    s_mov_b64 exec, -1
    s_add_u32 s46, s43, s45
    v_pk_mul_f32 v[144:145], v[144:145], v[20:21] op_sel_hi:[1,0]
    v_pk_mul_f32 v[146:147], v[146:147], v[20:21] op_sel_hi:[1,0]
    v_pk_mul_f32 v[148:149], v[148:149], v[20:21] op_sel_hi:[1,0]
    v_pk_mul_f32 v[150:151], v[150:151], v[20:21] op_sel_hi:[1,0]
    v_pk_mul_f32 v[152:153], v[152:153], v[20:21] op_sel_hi:[1,0]
    v_pk_mul_f32 v[154:155], v[154:155], v[20:21] op_sel_hi:[1,0]
    v_pk_mul_f32 v[156:157], v[156:157], v[20:21] op_sel_hi:[1,0]
    v_pk_mul_f32 v[158:159], v[158:159], v[20:21] op_sel_hi:[1,0]
    v_cvt_pk_bf16_f32 v144, v144, v145
    v_cvt_pk_bf16_f32 v145, v146, v147
    v_cvt_pk_bf16_f32 v146, v148, v149
    v_cvt_pk_bf16_f32 v147, v150, v151
    v_cvt_pk_bf16_f32 v148, v152, v153
    v_cvt_pk_bf16_f32 v149, v154, v155
    v_cvt_pk_bf16_f32 v150, v156, v157
    v_cvt_pk_bf16_f32 v151, v158, v159
    s_cmp_lg_u32 s49, 0
    s_cselect_b32 exec_lo, -1, 0
    s_cmp_lg_u32 s49, 1
    s_cselect_b32 exec_hi, -1, 0
    buffer_store_dwordx4 v[144:147], v18, s[20:23], s46 offen offset:0 sc1
    s_not_b64 exec, exec
    s_cbranch_execz k1q_s110
    buffer_store_dwordx2 v[144:145], v19, s[20:23], s46 offen offset:0 sc1
    buffer_store_dwordx2 v[146:147], v19, s[20:23], s46 offen offset:256 sc1
k1q_s110:
    s_cmp_lg_u32 s49, 2
    s_cselect_b32 exec_lo, -1, 0
    s_cmp_lg_u32 s49, 3
    s_cselect_b32 exec_hi, -1, 0
    buffer_store_dwordx4 v[148:151], v18, s[20:23], s46 offen offset:1024 sc1
    s_not_b64 exec, exec
    s_cbranch_execz k1q_s111
    buffer_store_dwordx2 v[148:149], v19, s[20:23], s46 offen offset:1024 sc1
    buffer_store_dwordx2 v[150:151], v19, s[20:23], s46 offen offset:1280 sc1
k1q_s111:
    s_mov_b64 exec, -1
    s_endpgm
k1_vbody:
    s_barrier
    ds_read_b128 v[32:35], v5
    ds_read_b64_tr_b16 v[40:41], v13 offset:0
    ds_read_b64_tr_b16 v[42:43], v13 offset:1024
    ds_read_b64_tr_b16 v[44:45], v14 offset:0
    ds_read_b64_tr_b16 v[46:47], v14 offset:1024
    ds_read_b128 v[36:39], v5 offset:4096
    ds_read_b128 v[48:51], v6
    ds_read_b64_tr_b16 v[56:57], v13 offset:4096
    ds_read_b64_tr_b16 v[58:59], v13 offset:5120
    ds_read_b64_tr_b16 v[60:61], v14 offset:4096
    ds_read_b64_tr_b16 v[62:63], v14 offset:5120
    ds_read_b128 v[52:55], v6 offset:4096
k1v_loop:
    s_and_b32 s32, s27, 3
    s_cmp_eq_u32 s32, 3
    s_cselect_b32 s33, s35, s36
    s_waitcnt lgkmcnt(6)
    v_mfma_f32_32x32x16_bf16 v[96:111], v[32:35], v[40:43], v[96:111]
    ds_read_b128 v[64:67], v7
    ds_read_b64_tr_b16 v[72:73], v13 offset:8192
    v_mfma_f32_32x32x16_bf16 v[112:127], v[32:35], v[44:47], v[112:127]
    ds_read_b64_tr_b16 v[74:75], v13 offset:9216
    ds_read_b64_tr_b16 v[76:77], v14 offset:8192
    v_mfma_f32_32x32x16_bf16 v[128:143], v[36:39], v[40:43], v[128:143]
    ds_read_b64_tr_b16 v[78:79], v14 offset:9216
    v_add_u32 v5, s33, v5
    v_mfma_f32_32x32x16_bf16 v[144:159], v[36:39], v[44:47], v[144:159]
    ds_read_b128 v[68:71], v7 offset:4096
    v_add_u32 v6, s33, v6
    v_mfma_f32_16x16x32_bf16 v[16:19], v[20:23], v[40:43], v[16:19]
    s_waitcnt lgkmcnt(6)
    v_mfma_f32_32x32x16_bf16 v[96:111], v[48:51], v[56:59], v[96:111]
    ds_read_b128 v[80:83], v8
    ds_read_b64_tr_b16 v[88:89], v13 offset:12288
    v_mfma_f32_32x32x16_bf16 v[112:127], v[48:51], v[60:63], v[112:127]
    ds_read_b64_tr_b16 v[90:91], v13 offset:13312
    ds_read_b64_tr_b16 v[92:93], v14 offset:12288
    v_mfma_f32_32x32x16_bf16 v[128:143], v[52:55], v[56:59], v[128:143]
    ds_read_b64_tr_b16 v[94:95], v14 offset:13312
    v_add_u32 v7, s33, v7
    v_add_u32 v13, s33, v13
    v_mfma_f32_32x32x16_bf16 v[144:159], v[52:55], v[60:63], v[144:159]
    ds_read_b128 v[84:87], v8 offset:4096
    v_add_u32 v14, s33, v14
    v_add_u32 v8, s33, v8
    v_mfma_f32_16x16x32_bf16 v[16:19], v[20:23], v[56:59], v[16:19]
    s_add_u32 s27, s27, 1
    s_cmp_eq_u32 s27, 10
    s_waitcnt lgkmcnt(6)
    s_cbranch_scc1 k1v_nb
    s_barrier
k1v_nb:
    v_mfma_f32_32x32x16_bf16 v[96:111], v[64:67], v[72:75], v[96:111]
    ds_read_b128 v[32:35], v5
    ds_read_b64_tr_b16 v[40:41], v13 offset:0
    v_mfma_f32_32x32x16_bf16 v[112:127], v[64:67], v[76:79], v[112:127]
    ds_read_b64_tr_b16 v[42:43], v13 offset:1024
    ds_read_b64_tr_b16 v[44:45], v14 offset:0
    v_mfma_f32_32x32x16_bf16 v[128:143], v[68:71], v[72:75], v[128:143]
    ds_read_b64_tr_b16 v[46:47], v14 offset:1024
    v_mfma_f32_32x32x16_bf16 v[144:159], v[68:71], v[76:79], v[144:159]
    ds_read_b128 v[36:39], v5 offset:4096
    v_mfma_f32_16x16x32_bf16 v[16:19], v[20:23], v[72:75], v[16:19]
    s_waitcnt lgkmcnt(6)
    v_mfma_f32_32x32x16_bf16 v[96:111], v[80:83], v[88:91], v[96:111]
    ds_read_b128 v[48:51], v6
    ds_read_b64_tr_b16 v[56:57], v13 offset:4096
    v_mfma_f32_32x32x16_bf16 v[112:127], v[80:83], v[92:95], v[112:127]
    ds_read_b64_tr_b16 v[58:59], v13 offset:5120
    ds_read_b64_tr_b16 v[60:61], v14 offset:4096
    v_mfma_f32_32x32x16_bf16 v[128:143], v[84:87], v[88:91], v[128:143]
    ds_read_b64_tr_b16 v[62:63], v14 offset:5120
    v_mfma_f32_32x32x16_bf16 v[144:159], v[84:87], v[92:95], v[144:159]
    ds_read_b128 v[52:55], v6 offset:4096
    v_mfma_f32_16x16x32_bf16 v[16:19], v[20:23], v[88:91], v[16:19]
    s_cbranch_scc0 k1v_loop
    s_waitcnt vmcnt(0)
    v_and_b32 v24, 31, v1
    v_lshlrev_b32 v24, 2, v24
    s_lshr_b32 s31, s24, 1
    s_lshl_b32 s31, s31, 8
    s_add_u32 s31, s31, 131072
    v_add_u32 v9, s31, v24
    s_lshl_b32 s33, s38, 8
    s_add_u32 s33, s33, 132096
    v_lshl_add_u32 v10, v1, 2, s33
    v_lshrrev_b32 v11, 5, v1
    v_lshl_add_u32 v11, v11, 4, s31
    v_cvt_pk_bf16_f32 v26, v16, v16
    v_mov_b32 v23, 0
    v_and_b32 v26, 0xffff0000, v26
    v_mov_b32 v25, 0
    v_sub_f32 v16, v16, v26
    v_mov_b32 v27, 0
    v_cvt_pk_bf16_f32 v26, -v26, -v16
    v_mov_b32 v29, 0
    ds_write_b32 v10, v26
    v_xor_b32 v10, 256, v10
    s_lshl_b32 s42, s25, 2
    s_and_b32 s43, s24, 2
    s_waitcnt lgkmcnt(0)
    s_barrier
    ds_read_b32 v22, v9
    ds_read_b32 v24, v9 offset:128
    ds_read_b32 v28, v10
    ds_read_b128 v[32:35], v11 offset:512
    ds_read_b128 v[36:39], v11 offset:544
    ds_read_b128 v[40:43], v11 offset:576
    ds_read_b128 v[44:47], v11 offset:608
    ds_read_b128 v[48:51], v11 offset:640
    ds_read_b128 v[52:55], v11 offset:672
    ds_read_b128 v[56:59], v11 offset:704
    ds_read_b128 v[60:63], v11 offset:736
    s_waitcnt lgkmcnt(8)
    v_mfma_f32_32x32x8_bf16 v[96:111], v[22:23], v[26:27], v[96:111]
    v_mfma_f32_32x32x8_bf16 v[128:143], v[24:25], v[26:27], v[128:143]
    v_mfma_f32_32x32x8_bf16 v[112:127], v[22:23], v[28:29], v[112:127]
    v_mfma_f32_32x32x8_bf16 v[144:159], v[24:25], v[28:29], v[144:159]
    v_lshrrev_b32 v18, 5, v1
    v_mul_u32_u24 v18, 10240, v18
    v_and_b32 v19, 31, v1
    v_lshl_add_u32 v18, v19, 4, v18
    s_add_u32 s42, s42, s43
    s_mul_i32 s42, s42, 122880
    s_add_u32 s43, s42, 122880
    s_lshl_b32 s44, s26, 2
    s_add_u32 s44, s44, s38
    s_xor_b32 s45, s44, 1
    s_waitcnt lgkmcnt(0)
    s_lshl_b32 s44, s44, 9
    s_lshl_b32 s45, s45, 9
    s_add_u32 s44, s44, 61440
    s_add_u32 s45, s45, 61440
    s_add_u32 s46, s42, s44
    s_add_u32 s47, s46, 20480
    v_pk_mul_f32 v[96:97], v[96:97], v[32:33]
    v_pk_mul_f32 v[98:99], v[98:99], v[34:35]
    v_pk_mul_f32 v[100:101], v[100:101], v[36:37]
    v_pk_mul_f32 v[102:103], v[102:103], v[38:39]
    v_pk_mul_f32 v[104:105], v[104:105], v[40:41]
    v_pk_mul_f32 v[106:107], v[106:107], v[42:43]
    v_pk_mul_f32 v[108:109], v[108:109], v[44:45]
    v_pk_mul_f32 v[110:111], v[110:111], v[46:47]
    v_cvt_pk_bf16_f32 v96, v96, v97
    v_cvt_pk_bf16_f32 v97, v98, v99
    v_cvt_pk_bf16_f32 v98, v100, v101
    v_cvt_pk_bf16_f32 v99, v102, v103
    v_cvt_pk_bf16_f32 v100, v104, v105
    v_cvt_pk_bf16_f32 v101, v106, v107
    v_cvt_pk_bf16_f32 v102, v108, v109
    v_cvt_pk_bf16_f32 v103, v110, v111
    buffer_store_dwordx4 v[96:99], v18, s[20:23], s46 offen sc1
    buffer_store_dwordx4 v[100:103], v18, s[20:23], s47 offen sc1
    s_add_u32 s46, s43, s44
    s_add_u32 s47, s46, 20480
    v_pk_mul_f32 v[128:129], v[128:129], v[48:49]
    v_pk_mul_f32 v[130:131], v[130:131], v[50:51]
    v_pk_mul_f32 v[132:133], v[132:133], v[52:53]
    v_pk_mul_f32 v[134:135], v[134:135], v[54:55]
    v_pk_mul_f32 v[136:137], v[136:137], v[56:57]
    v_pk_mul_f32 v[138:139], v[138:139], v[58:59]
    v_pk_mul_f32 v[140:141], v[140:141], v[60:61]
    v_pk_mul_f32 v[142:143], v[142:143], v[62:63]
    v_cvt_pk_bf16_f32 v128, v128, v129
    v_cvt_pk_bf16_f32 v129, v130, v131
    v_cvt_pk_bf16_f32 v130, v132, v133
    v_cvt_pk_bf16_f32 v131, v134, v135
    v_cvt_pk_bf16_f32 v132, v136, v137
    v_cvt_pk_bf16_f32 v133, v138, v139
    v_cvt_pk_bf16_f32 v134, v140, v141
    v_cvt_pk_bf16_f32 v135, v142, v143
    buffer_store_dwordx4 v[128:131], v18, s[20:23], s46 offen sc1
    buffer_store_dwordx4 v[132:135], v18, s[20:23], s47 offen sc1
    s_add_u32 s46, s42, s45
    s_add_u32 s47, s46, 20480
    v_pk_mul_f32 v[112:113], v[112:113], v[32:33]
    v_pk_mul_f32 v[114:115], v[114:115], v[34:35]
    v_pk_mul_f32 v[116:117], v[116:117], v[36:37]
    v_pk_mul_f32 v[118:119], v[118:119], v[38:39]
    v_pk_mul_f32 v[120:121], v[120:121], v[40:41]
    v_pk_mul_f32 v[122:123], v[122:123], v[42:43]
    v_pk_mul_f32 v[124:125], v[124:125], v[44:45]
    v_pk_mul_f32 v[126:127], v[126:127], v[46:47]
    v_cvt_pk_bf16_f32 v112, v112, v113
    v_cvt_pk_bf16_f32 v113, v114, v115
    v_cvt_pk_bf16_f32 v114, v116, v117
    v_cvt_pk_bf16_f32 v115, v118, v119
    v_cvt_pk_bf16_f32 v116, v120, v121
    v_cvt_pk_bf16_f32 v117, v122, v123
    v_cvt_pk_bf16_f32 v118, v124, v125
    v_cvt_pk_bf16_f32 v119, v126, v127
    buffer_store_dwordx4 v[112:115], v18, s[20:23], s46 offen sc1
    buffer_store_dwordx4 v[116:119], v18, s[20:23], s47 offen sc1
    s_add_u32 s46, s43, s45
    s_add_u32 s47, s46, 20480
    v_pk_mul_f32 v[144:145], v[144:145], v[48:49]
    v_pk_mul_f32 v[146:147], v[146:147], v[50:51]
    v_pk_mul_f32 v[148:149], v[148:149], v[52:53]
    v_pk_mul_f32 v[150:151], v[150:151], v[54:55]
    v_pk_mul_f32 v[152:153], v[152:153], v[56:57]
    v_pk_mul_f32 v[154:155], v[154:155], v[58:59]
    v_pk_mul_f32 v[156:157], v[156:157], v[60:61]
    v_pk_mul_f32 v[158:159], v[158:159], v[62:63]
    v_cvt_pk_bf16_f32 v144, v144, v145
    v_cvt_pk_bf16_f32 v145, v146, v147
    v_cvt_pk_bf16_f32 v146, v148, v149
    v_cvt_pk_bf16_f32 v147, v150, v151
    v_cvt_pk_bf16_f32 v148, v152, v153
    v_cvt_pk_bf16_f32 v149, v154, v155
    v_cvt_pk_bf16_f32 v150, v156, v157
    v_cvt_pk_bf16_f32 v151, v158, v159
    buffer_store_dwordx4 v[144:147], v18, s[20:23], s46 offen sc1
    buffer_store_dwordx4 v[148:151], v18, s[20:23], s47 offen sc1
    s_endpgm
k1_router:
    s_load_dwordx2 s[6:7], s[0:1], 32
    v_and_b32 v3, 15, v1
    v_lshlrev_b32 v4, 4, v3
    v_lshrrev_b32 v5, 4, v1
    v_mul_u32_u24 v5, 1280, v5
    v_add_u32 v5, v5, v4
    s_lshl_b32 s28, s25, 3
    s_add_u32 s28, s28, s24
    s_mul_i32 s28, s28, 20480
    s_waitcnt lgkmcnt(0)
    s_mov_b32 s12, s4
    s_mov_b32 s13, s5
    s_mov_b32 s14, 2621440
    s_mov_b32 s15, 0x20000
    s_mov_b32 s16, s6
    s_mov_b32 s17, s7
    s_mov_b32 s18, 1280
    s_mov_b32 s19, 0x20000
    buffer_load_dwordx4 v[44:47], v5, s[12:15], s28 offen offset:0
    buffer_load_dwordx4 v[48:51], v5, s[12:15], s28 offen offset:256
    buffer_load_dwordx4 v[52:55], v5, s[12:15], s28 offen offset:512
    buffer_load_dwordx4 v[56:59], v5, s[12:15], s28 offen offset:768
    buffer_load_dwordx4 v[60:63], v5, s[12:15], s28 offen offset:1024
    s_addk_i32 s28, 5120
    buffer_load_dwordx4 v[64:67], v5, s[12:15], s28 offen offset:0
    buffer_load_dwordx4 v[68:71], v5, s[12:15], s28 offen offset:256
    buffer_load_dwordx4 v[72:75], v5, s[12:15], s28 offen offset:512
    buffer_load_dwordx4 v[76:79], v5, s[12:15], s28 offen offset:768
    buffer_load_dwordx4 v[80:83], v5, s[12:15], s28 offen offset:1024
    s_addk_i32 s28, 5120
    s_mov_b32 s20, s10
    s_mov_b32 s21, s11
    s_mov_b32 s22, 11634688
    s_mov_b32 s23, 0x20000
    s_mov_b32 s34, 0x3f803f80
    s_mov_b32 s40, 0x00010001
    s_mov_b32 s41, 0x00010001
    v_mov_b32 v9, 0
    v_mov_b32 v10, 0
    v_mov_b32 v11, 0
    v_mov_b32 v12, 0
    v_mov_b32 v6, 0
    v_mov_b32 v7, 0
    v_mov_b32 v8, 0
    v_mov_b32 v13, 0
    s_waitcnt vmcnt(5)
    buffer_load_dwordx4 v[84:87], v5, s[12:15], s28 offen offset:0
    buffer_load_dwordx4 v[88:91], v5, s[12:15], s28 offen offset:256
    buffer_load_dwordx4 v[92:95], v5, s[12:15], s28 offen offset:512
    buffer_load_dwordx4 v[96:99], v5, s[12:15], s28 offen offset:768
    buffer_load_dwordx4 v[100:103], v5, s[12:15], s28 offen offset:1024
    s_addk_i32 s28, 5120
    v_dot2c_f32_bf16 v6, s34, v44
    v_dot2c_f32_bf16 v7, v44, v44
    v_dot2c_f32_bf16 v8, s34, v45
    v_dot2c_f32_bf16 v13, v45, v45
    v_dot2c_f32_bf16 v6, s34, v46
    v_dot2c_f32_bf16 v7, v46, v46
    v_dot2c_f32_bf16 v8, s34, v47
    v_dot2c_f32_bf16 v13, v47, v47
    v_dot2c_f32_bf16 v6, s34, v48
    v_dot2c_f32_bf16 v7, v48, v48
    v_dot2c_f32_bf16 v8, s34, v49
    v_dot2c_f32_bf16 v13, v49, v49
    v_dot2c_f32_bf16 v6, s34, v50
    v_dot2c_f32_bf16 v7, v50, v50
    v_dot2c_f32_bf16 v8, s34, v51
    v_dot2c_f32_bf16 v13, v51, v51
    v_dot2c_f32_bf16 v6, s34, v52
    v_dot2c_f32_bf16 v7, v52, v52
    v_dot2c_f32_bf16 v8, s34, v53
    v_dot2c_f32_bf16 v13, v53, v53
    v_dot2c_f32_bf16 v6, s34, v54
    v_dot2c_f32_bf16 v7, v54, v54
    v_dot2c_f32_bf16 v8, s34, v55
    v_dot2c_f32_bf16 v13, v55, v55
    v_dot2c_f32_bf16 v6, s34, v56
    v_dot2c_f32_bf16 v7, v56, v56
    v_dot2c_f32_bf16 v8, s34, v57
    v_dot2c_f32_bf16 v13, v57, v57
    v_dot2c_f32_bf16 v6, s34, v58
    v_dot2c_f32_bf16 v7, v58, v58
    v_dot2c_f32_bf16 v8, s34, v59
    v_dot2c_f32_bf16 v13, v59, v59
    v_dot2c_f32_bf16 v6, s34, v60
    v_dot2c_f32_bf16 v7, v60, v60
    v_dot2c_f32_bf16 v8, s34, v61
    v_dot2c_f32_bf16 v13, v61, v61
    v_dot2c_f32_bf16 v6, s34, v62
    v_dot2c_f32_bf16 v7, v62, v62
    v_dot2c_f32_bf16 v8, s34, v63
    v_dot2c_f32_bf16 v13, v63, v63
    s_nop 1
    v_add_f32 v6, v6, v8
    s_nop 0
    v_add_f32 v7, v7, v13
    s_nop 0
    v_add_f32_dpp v6, v6, v6 row_ror:8 row_mask:0xf bank_mask:0xf
    v_add_f32_dpp v7, v7, v7 row_ror:8 row_mask:0xf bank_mask:0xf
    s_nop 0
    v_add_f32_dpp v6, v6, v6 row_ror:4 row_mask:0xf bank_mask:0xf
    v_add_f32_dpp v7, v7, v7 row_ror:4 row_mask:0xf bank_mask:0xf
    s_nop 0
    v_add_f32_dpp v6, v6, v6 row_ror:2 row_mask:0xf bank_mask:0xf
    v_add_f32_dpp v7, v7, v7 row_ror:2 row_mask:0xf bank_mask:0xf
    s_nop 0
    v_add_f32_dpp v6, v6, v6 row_ror:1 row_mask:0xf bank_mask:0xf
    v_add_f32_dpp v7, v7, v7 row_ror:1 row_mask:0xf bank_mask:0xf
    v_cndmask_b32 v10, v10, v6, s[40:41]
    v_cndmask_b32 v11, v11, v7, s[40:41]
    s_lshl_b64 s[40:41], s[40:41], 1
    v_mov_b32 v6, 0
    v_mov_b32 v7, 0
    v_mov_b32 v8, 0
    v_mov_b32 v13, 0
    s_waitcnt vmcnt(5)
    buffer_load_dwordx4 v[104:107], v5, s[12:15], s28 offen offset:0
    buffer_load_dwordx4 v[108:111], v5, s[12:15], s28 offen offset:256
    buffer_load_dwordx4 v[112:115], v5, s[12:15], s28 offen offset:512
    buffer_load_dwordx4 v[116:119], v5, s[12:15], s28 offen offset:768
    buffer_load_dwordx4 v[120:123], v5, s[12:15], s28 offen offset:1024
    s_addk_i32 s28, 5120
    v_dot2c_f32_bf16 v6, s34, v64
    v_dot2c_f32_bf16 v7, v64, v64
    v_dot2c_f32_bf16 v8, s34, v65
    v_dot2c_f32_bf16 v13, v65, v65
    v_dot2c_f32_bf16 v6, s34, v66
    v_dot2c_f32_bf16 v7, v66, v66
    v_dot2c_f32_bf16 v8, s34, v67
    v_dot2c_f32_bf16 v13, v67, v67
    v_dot2c_f32_bf16 v6, s34, v68
    v_dot2c_f32_bf16 v7, v68, v68
    v_dot2c_f32_bf16 v8, s34, v69
    v_dot2c_f32_bf16 v13, v69, v69
    v_dot2c_f32_bf16 v6, s34, v70
    v_dot2c_f32_bf16 v7, v70, v70
    v_dot2c_f32_bf16 v8, s34, v71
    v_dot2c_f32_bf16 v13, v71, v71
    v_dot2c_f32_bf16 v6, s34, v72
    v_dot2c_f32_bf16 v7, v72, v72
    v_dot2c_f32_bf16 v8, s34, v73
    v_dot2c_f32_bf16 v13, v73, v73
    v_dot2c_f32_bf16 v6, s34, v74
    v_dot2c_f32_bf16 v7, v74, v74
    v_dot2c_f32_bf16 v8, s34, v75
    v_dot2c_f32_bf16 v13, v75, v75
    v_dot2c_f32_bf16 v6, s34, v76
    v_dot2c_f32_bf16 v7, v76, v76
    v_dot2c_f32_bf16 v8, s34, v77
    v_dot2c_f32_bf16 v13, v77, v77
    v_dot2c_f32_bf16 v6, s34, v78
    v_dot2c_f32_bf16 v7, v78, v78
    v_dot2c_f32_bf16 v8, s34, v79
    v_dot2c_f32_bf16 v13, v79, v79
    v_dot2c_f32_bf16 v6, s34, v80
    v_dot2c_f32_bf16 v7, v80, v80
    v_dot2c_f32_bf16 v8, s34, v81
    v_dot2c_f32_bf16 v13, v81, v81
    v_dot2c_f32_bf16 v6, s34, v82
    v_dot2c_f32_bf16 v7, v82, v82
    v_dot2c_f32_bf16 v8, s34, v83
    v_dot2c_f32_bf16 v13, v83, v83
    s_nop 1
    v_add_f32 v6, v6, v8
    s_nop 0
    v_add_f32 v7, v7, v13
    s_nop 0
    v_add_f32_dpp v6, v6, v6 row_ror:8 row_mask:0xf bank_mask:0xf
    v_add_f32_dpp v7, v7, v7 row_ror:8 row_mask:0xf bank_mask:0xf
    s_nop 0
    v_add_f32_dpp v6, v6, v6 row_ror:4 row_mask:0xf bank_mask:0xf
    v_add_f32_dpp v7, v7, v7 row_ror:4 row_mask:0xf bank_mask:0xf
    s_nop 0
    v_add_f32_dpp v6, v6, v6 row_ror:2 row_mask:0xf bank_mask:0xf
    v_add_f32_dpp v7, v7, v7 row_ror:2 row_mask:0xf bank_mask:0xf
    s_nop 0
    v_add_f32_dpp v6, v6, v6 row_ror:1 row_mask:0xf bank_mask:0xf
    v_add_f32_dpp v7, v7, v7 row_ror:1 row_mask:0xf bank_mask:0xf
    v_cndmask_b32 v10, v10, v6, s[40:41]
    v_cndmask_b32 v11, v11, v7, s[40:41]
    s_lshl_b64 s[40:41], s[40:41], 1
    v_mov_b32 v6, 0
    v_mov_b32 v7, 0
    v_mov_b32 v8, 0
    v_mov_b32 v13, 0
    s_waitcnt vmcnt(5)
    buffer_load_dwordx4 v[24:27], v4, s[16:19], 0 offen offset:0
    buffer_load_dwordx4 v[28:31], v4, s[16:19], 0 offen offset:256
    buffer_load_dwordx4 v[32:35], v4, s[16:19], 0 offen offset:512
    buffer_load_dwordx4 v[36:39], v4, s[16:19], 0 offen offset:768
    buffer_load_dwordx4 v[40:43], v4, s[16:19], 0 offen offset:1024
    v_dot2c_f32_bf16 v6, s34, v84
    v_dot2c_f32_bf16 v7, v84, v84
    v_dot2c_f32_bf16 v8, s34, v85
    v_dot2c_f32_bf16 v13, v85, v85
    v_dot2c_f32_bf16 v6, s34, v86
    v_dot2c_f32_bf16 v7, v86, v86
    v_dot2c_f32_bf16 v8, s34, v87
    v_dot2c_f32_bf16 v13, v87, v87
    v_dot2c_f32_bf16 v6, s34, v88
    v_dot2c_f32_bf16 v7, v88, v88
    v_dot2c_f32_bf16 v8, s34, v89
    v_dot2c_f32_bf16 v13, v89, v89
    v_dot2c_f32_bf16 v6, s34, v90
    v_dot2c_f32_bf16 v7, v90, v90
    v_dot2c_f32_bf16 v8, s34, v91
    v_dot2c_f32_bf16 v13, v91, v91
    v_dot2c_f32_bf16 v6, s34, v92
    v_dot2c_f32_bf16 v7, v92, v92
    v_dot2c_f32_bf16 v8, s34, v93
    v_dot2c_f32_bf16 v13, v93, v93
    v_dot2c_f32_bf16 v6, s34, v94
    v_dot2c_f32_bf16 v7, v94, v94
    v_dot2c_f32_bf16 v8, s34, v95
    v_dot2c_f32_bf16 v13, v95, v95
    v_dot2c_f32_bf16 v6, s34, v96
    v_dot2c_f32_bf16 v7, v96, v96
    v_dot2c_f32_bf16 v8, s34, v97
    v_dot2c_f32_bf16 v13, v97, v97
    v_dot2c_f32_bf16 v6, s34, v98
    v_dot2c_f32_bf16 v7, v98, v98
    v_dot2c_f32_bf16 v8, s34, v99
    v_dot2c_f32_bf16 v13, v99, v99
    v_dot2c_f32_bf16 v6, s34, v100
    v_dot2c_f32_bf16 v7, v100, v100
    v_dot2c_f32_bf16 v8, s34, v101
    v_dot2c_f32_bf16 v13, v101, v101
    v_dot2c_f32_bf16 v6, s34, v102
    v_dot2c_f32_bf16 v7, v102, v102
    v_dot2c_f32_bf16 v8, s34, v103
    v_dot2c_f32_bf16 v13, v103, v103
    s_nop 1
    v_add_f32 v6, v6, v8
    s_nop 0
    v_add_f32 v7, v7, v13
    s_nop 0
    v_add_f32_dpp v6, v6, v6 row_ror:8 row_mask:0xf bank_mask:0xf
    v_add_f32_dpp v7, v7, v7 row_ror:8 row_mask:0xf bank_mask:0xf
    s_nop 0
    v_add_f32_dpp v6, v6, v6 row_ror:4 row_mask:0xf bank_mask:0xf
    v_add_f32_dpp v7, v7, v7 row_ror:4 row_mask:0xf bank_mask:0xf
    s_nop 0
    v_add_f32_dpp v6, v6, v6 row_ror:2 row_mask:0xf bank_mask:0xf
    v_add_f32_dpp v7, v7, v7 row_ror:2 row_mask:0xf bank_mask:0xf
    s_nop 0
    v_add_f32_dpp v6, v6, v6 row_ror:1 row_mask:0xf bank_mask:0xf
    v_add_f32_dpp v7, v7, v7 row_ror:1 row_mask:0xf bank_mask:0xf
    v_cndmask_b32 v10, v10, v6, s[40:41]
    v_cndmask_b32 v11, v11, v7, s[40:41]
    s_lshl_b64 s[40:41], s[40:41], 1
    v_mov_b32 v6, 0
    v_mov_b32 v7, 0
    v_mov_b32 v8, 0
    v_mov_b32 v13, 0
    s_waitcnt vmcnt(5)
    v_dot2c_f32_bf16 v6, s34, v104
    v_dot2c_f32_bf16 v7, v104, v104
    v_dot2c_f32_bf16 v8, s34, v105
    v_dot2c_f32_bf16 v13, v105, v105
    v_dot2c_f32_bf16 v6, s34, v106
    v_dot2c_f32_bf16 v7, v106, v106
    v_dot2c_f32_bf16 v8, s34, v107
    v_dot2c_f32_bf16 v13, v107, v107
    v_dot2c_f32_bf16 v6, s34, v108
    v_dot2c_f32_bf16 v7, v108, v108
    v_dot2c_f32_bf16 v8, s34, v109
    v_dot2c_f32_bf16 v13, v109, v109
    v_dot2c_f32_bf16 v6, s34, v110
    v_dot2c_f32_bf16 v7, v110, v110
    v_dot2c_f32_bf16 v8, s34, v111
    v_dot2c_f32_bf16 v13, v111, v111
    v_dot2c_f32_bf16 v6, s34, v112
    v_dot2c_f32_bf16 v7, v112, v112
    v_dot2c_f32_bf16 v8, s34, v113
    v_dot2c_f32_bf16 v13, v113, v113
    v_dot2c_f32_bf16 v6, s34, v114
    v_dot2c_f32_bf16 v7, v114, v114
    v_dot2c_f32_bf16 v8, s34, v115
    v_dot2c_f32_bf16 v13, v115, v115
    v_dot2c_f32_bf16 v6, s34, v116
    v_dot2c_f32_bf16 v7, v116, v116
    v_dot2c_f32_bf16 v8, s34, v117
    v_dot2c_f32_bf16 v13, v117, v117
    v_dot2c_f32_bf16 v6, s34, v118
    v_dot2c_f32_bf16 v7, v118, v118
    v_dot2c_f32_bf16 v8, s34, v119
    v_dot2c_f32_bf16 v13, v119, v119
    v_dot2c_f32_bf16 v6, s34, v120
    v_dot2c_f32_bf16 v7, v120, v120
    v_dot2c_f32_bf16 v8, s34, v121
    v_dot2c_f32_bf16 v13, v121, v121
    v_dot2c_f32_bf16 v6, s34, v122
    v_dot2c_f32_bf16 v7, v122, v122
    v_dot2c_f32_bf16 v8, s34, v123
    v_dot2c_f32_bf16 v13, v123, v123
    s_nop 1
    v_add_f32 v6, v6, v8
    s_nop 0
    v_add_f32 v7, v7, v13
    s_nop 0
    v_add_f32_dpp v6, v6, v6 row_ror:8 row_mask:0xf bank_mask:0xf
    v_add_f32_dpp v7, v7, v7 row_ror:8 row_mask:0xf bank_mask:0xf
    s_nop 0
    v_add_f32_dpp v6, v6, v6 row_ror:4 row_mask:0xf bank_mask:0xf
    v_add_f32_dpp v7, v7, v7 row_ror:4 row_mask:0xf bank_mask:0xf
    s_nop 0
    v_add_f32_dpp v6, v6, v6 row_ror:2 row_mask:0xf bank_mask:0xf
    v_add_f32_dpp v7, v7, v7 row_ror:2 row_mask:0xf bank_mask:0xf
    s_nop 0
    v_add_f32_dpp v6, v6, v6 row_ror:1 row_mask:0xf bank_mask:0xf
    v_add_f32_dpp v7, v7, v7 row_ror:1 row_mask:0xf bank_mask:0xf
    v_cndmask_b32 v10, v10, v6, s[40:41]
    v_cndmask_b32 v11, v11, v7, s[40:41]
    v_mul_f32 v10, 0x3acccccd, v10
    v_mul_f32 v11, 0x3acccccd, v11
    v_fma_f32 v11, -v10, v10, v11
    v_max_f32 v11, 0, v11
    v_cvt_pk_bf16_f32 v14, v10, v10
    v_cvt_pk_bf16_f32 v16, v11, v11
    v_and_b32 v16, 0xffff0000, v16
    v_add_f32 v16, 0x3727c5ac, v16
    v_cvt_pk_bf16_f32 v16, v16, v16
    v_and_b32 v16, 0xffff0000, v16
    v_sqrt_f32 v16, v16
    s_nop 0
    v_cvt_pk_bf16_f32 v16, v16, v16
    v_and_b32 v15, 0xffff0000, v16
    v_and_b32 v14, 0xffff0000, v14
    v_lshrrev_b32 v17, 4, v1
    v_lshl_add_u32 v17, v3, 2, v17
    s_lshl_b32 s31, s24, 4
    v_add_u32 v17, s31, v17
    s_lshl_b32 s31, s25, 7
    v_add_u32 v18, s31, v17
    v_lshlrev_b32 v21, 2, v18
    v_lshrrev_b32 v22, 16, v14
    v_or_b32 v22, v22, v15
    s_mov_b32 s42, 0x000f000f
    s_mov_b32 s43, 0x000f000f
    s_mov_b64 exec, s[42:43]
    s_mov_b32 s31, 10485760
    buffer_store_dword v22, v21, s[20:23], s31 offen sc1
    s_mov_b64 exec, -1
    s_waitcnt vmcnt(0)
    s_barrier
    s_cmp_lg_u32 s24, 0
    s_cbranch_scc1 k1r_nf
    s_lshl_b32 s31, s25, 2
    v_mov_b32 v4, s31
    v_mov_b32 v5, 1
    s_mov_b64 exec, 1
    global_store_dword v4, v5, s[8:9] sc1
    s_mov_b64 exec, -1
k1r_nf:
    v_mov_b32 v6, 0
    v_mov_b32 v7, 0
    v_mov_b32 v8, 0
    v_mov_b32 v13, 0
    v_dot2c_f32_bf16 v6, v24, v44
    v_dot2c_f32_bf16 v7, v24, v64
    v_dot2c_f32_bf16 v8, v24, v84
    v_dot2c_f32_bf16 v13, v24, v104
    v_dot2c_f32_bf16 v9, s34, v24
    v_dot2c_f32_bf16 v6, v25, v45
    v_dot2c_f32_bf16 v7, v25, v65
    v_dot2c_f32_bf16 v8, v25, v85
    v_dot2c_f32_bf16 v13, v25, v105
    v_dot2c_f32_bf16 v9, s34, v25
    v_dot2c_f32_bf16 v6, v26, v46
    v_dot2c_f32_bf16 v7, v26, v66
    v_dot2c_f32_bf16 v8, v26, v86
    v_dot2c_f32_bf16 v13, v26, v106
    v_dot2c_f32_bf16 v9, s34, v26
    v_dot2c_f32_bf16 v6, v27, v47
    v_dot2c_f32_bf16 v7, v27, v67
    v_dot2c_f32_bf16 v8, v27, v87
    v_dot2c_f32_bf16 v13, v27, v107
    v_dot2c_f32_bf16 v9, s34, v27
    v_dot2c_f32_bf16 v6, v28, v48
    v_dot2c_f32_bf16 v7, v28, v68
    v_dot2c_f32_bf16 v8, v28, v88
    v_dot2c_f32_bf16 v13, v28, v108
    v_dot2c_f32_bf16 v9, s34, v28
    v_dot2c_f32_bf16 v6, v29, v49
    v_dot2c_f32_bf16 v7, v29, v69
    v_dot2c_f32_bf16 v8, v29, v89
    v_dot2c_f32_bf16 v13, v29, v109
    v_dot2c_f32_bf16 v9, s34, v29
    v_dot2c_f32_bf16 v6, v30, v50
    v_dot2c_f32_bf16 v7, v30, v70
    v_dot2c_f32_bf16 v8, v30, v90
    v_dot2c_f32_bf16 v13, v30, v110
    v_dot2c_f32_bf16 v9, s34, v30
    v_dot2c_f32_bf16 v6, v31, v51
    v_dot2c_f32_bf16 v7, v31, v71
    v_dot2c_f32_bf16 v8, v31, v91
    v_dot2c_f32_bf16 v13, v31, v111
    v_dot2c_f32_bf16 v9, s34, v31
    v_dot2c_f32_bf16 v6, v32, v52
    v_dot2c_f32_bf16 v7, v32, v72
    v_dot2c_f32_bf16 v8, v32, v92
    v_dot2c_f32_bf16 v13, v32, v112
    v_dot2c_f32_bf16 v9, s34, v32
    v_dot2c_f32_bf16 v6, v33, v53
    v_dot2c_f32_bf16 v7, v33, v73
    v_dot2c_f32_bf16 v8, v33, v93
    v_dot2c_f32_bf16 v13, v33, v113
    v_dot2c_f32_bf16 v9, s34, v33
    v_dot2c_f32_bf16 v6, v34, v54
    v_dot2c_f32_bf16 v7, v34, v74
    v_dot2c_f32_bf16 v8, v34, v94
    v_dot2c_f32_bf16 v13, v34, v114
    v_dot2c_f32_bf16 v9, s34, v34
    v_dot2c_f32_bf16 v6, v35, v55
    v_dot2c_f32_bf16 v7, v35, v75
    v_dot2c_f32_bf16 v8, v35, v95
    v_dot2c_f32_bf16 v13, v35, v115
    v_dot2c_f32_bf16 v9, s34, v35
    v_dot2c_f32_bf16 v6, v36, v56
    v_dot2c_f32_bf16 v7, v36, v76
    v_dot2c_f32_bf16 v8, v36, v96
    v_dot2c_f32_bf16 v13, v36, v116
    v_dot2c_f32_bf16 v9, s34, v36
    v_dot2c_f32_bf16 v6, v37, v57
    v_dot2c_f32_bf16 v7, v37, v77
    v_dot2c_f32_bf16 v8, v37, v97
    v_dot2c_f32_bf16 v13, v37, v117
    v_dot2c_f32_bf16 v9, s34, v37
    v_dot2c_f32_bf16 v6, v38, v58
    v_dot2c_f32_bf16 v7, v38, v78
    v_dot2c_f32_bf16 v8, v38, v98
    v_dot2c_f32_bf16 v13, v38, v118
    v_dot2c_f32_bf16 v9, s34, v38
    v_dot2c_f32_bf16 v6, v39, v59
    v_dot2c_f32_bf16 v7, v39, v79
    v_dot2c_f32_bf16 v8, v39, v99
    v_dot2c_f32_bf16 v13, v39, v119
    v_dot2c_f32_bf16 v9, s34, v39
    v_dot2c_f32_bf16 v6, v40, v60
    v_dot2c_f32_bf16 v7, v40, v80
    v_dot2c_f32_bf16 v8, v40, v100
    v_dot2c_f32_bf16 v13, v40, v120
    v_dot2c_f32_bf16 v9, s34, v40
    v_dot2c_f32_bf16 v6, v41, v61
    v_dot2c_f32_bf16 v7, v41, v81
    v_dot2c_f32_bf16 v8, v41, v101
    v_dot2c_f32_bf16 v13, v41, v121
    v_dot2c_f32_bf16 v9, s34, v41
    v_dot2c_f32_bf16 v6, v42, v62
    v_dot2c_f32_bf16 v7, v42, v82
    v_dot2c_f32_bf16 v8, v42, v102
    v_dot2c_f32_bf16 v13, v42, v122
    v_dot2c_f32_bf16 v9, s34, v42
    v_dot2c_f32_bf16 v6, v43, v63
    v_dot2c_f32_bf16 v7, v43, v83
    v_dot2c_f32_bf16 v8, v43, v103
    v_dot2c_f32_bf16 v13, v43, v123
    v_dot2c_f32_bf16 v9, s34, v43
    s_mov_b32 s40, 0x00010001
    s_mov_b32 s41, 0x00010001
    s_nop 0
    v_add_f32_dpp v6, v6, v6 row_ror:8 row_mask:0xf bank_mask:0xf
    v_add_f32_dpp v7, v7, v7 row_ror:8 row_mask:0xf bank_mask:0xf
    v_add_f32_dpp v8, v8, v8 row_ror:8 row_mask:0xf bank_mask:0xf
    v_add_f32_dpp v13, v13, v13 row_ror:8 row_mask:0xf bank_mask:0xf
    v_add_f32_dpp v9, v9, v9 row_ror:8 row_mask:0xf bank_mask:0xf
    v_add_f32_dpp v6, v6, v6 row_ror:4 row_mask:0xf bank_mask:0xf
    v_add_f32_dpp v7, v7, v7 row_ror:4 row_mask:0xf bank_mask:0xf
    v_add_f32_dpp v8, v8, v8 row_ror:4 row_mask:0xf bank_mask:0xf
    v_add_f32_dpp v13, v13, v13 row_ror:4 row_mask:0xf bank_mask:0xf
    v_add_f32_dpp v9, v9, v9 row_ror:4 row_mask:0xf bank_mask:0xf
    v_add_f32_dpp v6, v6, v6 row_ror:2 row_mask:0xf bank_mask:0xf
    v_add_f32_dpp v7, v7, v7 row_ror:2 row_mask:0xf bank_mask:0xf
    v_add_f32_dpp v8, v8, v8 row_ror:2 row_mask:0xf bank_mask:0xf
    v_add_f32_dpp v13, v13, v13 row_ror:2 row_mask:0xf bank_mask:0xf
    v_add_f32_dpp v9, v9, v9 row_ror:2 row_mask:0xf bank_mask:0xf
    v_add_f32_dpp v6, v6, v6 row_ror:1 row_mask:0xf bank_mask:0xf
    v_add_f32_dpp v7, v7, v7 row_ror:1 row_mask:0xf bank_mask:0xf
    v_add_f32_dpp v8, v8, v8 row_ror:1 row_mask:0xf bank_mask:0xf
    v_add_f32_dpp v13, v13, v13 row_ror:1 row_mask:0xf bank_mask:0xf
    v_add_f32_dpp v9, v9, v9 row_ror:1 row_mask:0xf bank_mask:0xf
    v_cndmask_b32 v12, v12, v6, s[40:41]
    s_lshl_b64 s[40:41], s[40:41], 1
    v_cndmask_b32 v12, v12, v7, s[40:41]
    s_lshl_b64 s[40:41], s[40:41], 1
    v_cndmask_b32 v12, v12, v8, s[40:41]
    s_lshl_b64 s[40:41], s[40:41], 1
    v_cndmask_b32 v12, v12, v13, s[40:41]
    s_lshl_b64 s[40:41], s[40:41], 1
    s_mov_b64 exec, s[42:43]
    v_rcp_f32 v16, v15
    v_fma_f32 v12, -v14, v9, v12
    v_mul_f32 v12, v12, v16
    v_cvt_pk_bf16_f32 v12, v12, v12
    v_ashrrev_i32 v13, 31, v12
    v_or_b32 v13, 0x80000000, v13
    v_xor_b32 v12, v12, v13
    v_and_b32 v12, 0xffff0000, v12
    v_sub_u32 v19, 2047, v18
    v_lshl_or_b32 v12, v19, 3, v12
    v_lshlrev_b32 v19, 2, v17
    v_lshlrev_b32 v20, 3, v17
    ds_write_b32 v19, v12
    ds_write_b64 v20, v[14:15] offset:512
    s_mov_b64 exec, -1
    v_lshlrev_b32 v2, 3, v1
    s_waitcnt lgkmcnt(0)
    s_barrier
    ds_read_b64 v[6:7], v2
    v_mov_b32 v9, 0
    s_mov_b32 s27, 0
    s_waitcnt lgkmcnt(0)
k1r_top:
    v_max_u32 v8, v6, v7
    s_nop 1
    v_max_u32_dpp v8, v8, v8 row_ror:8 row_mask:0xf bank_mask:0xf
    s_nop 1
    v_max_u32_dpp v8, v8, v8 row_ror:4 row_mask:0xf bank_mask:0xf
    s_nop 1
    v_max_u32_dpp v8, v8, v8 row_ror:2 row_mask:0xf bank_mask:0xf
    s_nop 1
    v_max_u32_dpp v8, v8, v8 row_ror:1 row_mask:0xf bank_mask:0xf
    s_nop 1
    v_max_u32_dpp v8, v8, v8 row_bcast:15 row_mask:0xa bank_mask:0xf
    s_nop 1
    v_max_u32_dpp v8, v8, v8 row_bcast:31 row_mask:0xc bank_mask:0xf
    s_nop 1
    v_readlane_b32 s31, v8, 63
    s_or_b32 s33, s31, s27
    s_mov_b32 m0, s27
    v_cmp_ne_u32 s[40:41], s31, v6
    v_cmp_ne_u32 s[42:43], s31, v7
    v_writelane_b32 v9, s33, m0
    s_add_u32 s27, s27, 1
    v_cndmask_b32 v6, 0, v6, s[40:41]
    v_cndmask_b32 v7, 0, v7, s[42:43]
    s_cmp_le_u32 s27, s24
    s_cbranch_scc1 k1r_top
    s_lshl_b32 s35, s25, 3
    s_add_u32 s35, s35, s24
    s_bfe_u32 s31, s33, 0xb0003
    s_sub_u32 s31, 2047, s31
    s_and_b32 s36, s31, 127
    s_lshl_b32 s36, s36, 3
    v_mov_b32 v4, s36
    ds_read_b64 v[14:15], v4 offset:512
    s_mul_i32 s31, s31, 1280
    v_lshlrev_b32 v6, 4, v1
    v_lshlrev_b32 v7, 2, v1
    buffer_load_dwordx4 v[32:35], v6, s[12:15], s31 offen
    buffer_load_dword v36, v7, s[12:15], s31 offen offset:1024
    s_lshl_b32 s36, s35, 2
    s_add_u32 s36, s36, 10502144
    v_mov_b32 v4, 0
    v_mov_b32 v5, s33
    s_mov_b64 exec, 1
    buffer_store_dword v5, v4, s[20:23], s36 offen
    s_mov_b64 exec, -1
    s_mul_i32 s35, s35, 1280
    s_add_u32 s35, s35, 10553344
    s_waitcnt lgkmcnt(0)
    v_rcp_f32 v16, v15
    v_sub_f32 v14, 0, v14
    s_waitcnt vmcnt(1)
    v_lshlrev_b32 v18, 16, v32
    v_and_b32 v19, 0xffff0000, v32
    v_pk_add_f32 v[18:19], v[18:19], v[14:15] op_sel_hi:[1,0]
    v_cvt_pk_bf16_f32 v32, v18, v19
    v_lshlrev_b32 v18, 16, v32
    v_and_b32 v19, 0xffff0000, v32
    v_pk_mul_f32 v[18:19], v[18:19], v[16:17] op_sel_hi:[1,0]
    v_cvt_pk_bf16_f32 v32, v18, v19
    v_lshlrev_b32 v18, 16, v33
    v_and_b32 v19, 0xffff0000, v33
    v_pk_add_f32 v[18:19], v[18:19], v[14:15] op_sel_hi:[1,0]
    v_cvt_pk_bf16_f32 v33, v18, v19
    v_lshlrev_b32 v18, 16, v33
    v_and_b32 v19, 0xffff0000, v33
    v_pk_mul_f32 v[18:19], v[18:19], v[16:17] op_sel_hi:[1,0]
    v_cvt_pk_bf16_f32 v33, v18, v19
    v_lshlrev_b32 v18, 16, v34
    v_and_b32 v19, 0xffff0000, v34
    v_pk_add_f32 v[18:19], v[18:19], v[14:15] op_sel_hi:[1,0]
    v_cvt_pk_bf16_f32 v34, v18, v19
    v_lshlrev_b32 v18, 16, v34
    v_and_b32 v19, 0xffff0000, v34
    v_pk_mul_f32 v[18:19], v[18:19], v[16:17] op_sel_hi:[1,0]
    v_cvt_pk_bf16_f32 v34, v18, v19
    v_lshlrev_b32 v18, 16, v35
    v_and_b32 v19, 0xffff0000, v35
    v_pk_add_f32 v[18:19], v[18:19], v[14:15] op_sel_hi:[1,0]
    v_cvt_pk_bf16_f32 v35, v18, v19
    v_lshlrev_b32 v18, 16, v35
    v_and_b32 v19, 0xffff0000, v35
    v_pk_mul_f32 v[18:19], v[18:19], v[16:17] op_sel_hi:[1,0]
    v_cvt_pk_bf16_f32 v35, v18, v19
    v_lshlrev_b32 v18, 16, v36
    v_and_b32 v19, 0xffff0000, v36
    v_pk_add_f32 v[18:19], v[18:19], v[14:15] op_sel_hi:[1,0]
    v_cvt_pk_bf16_f32 v36, v18, v19
    v_lshlrev_b32 v18, 16, v36
    v_and_b32 v19, 0xffff0000, v36
    v_pk_mul_f32 v[18:19], v[18:19], v[16:17] op_sel_hi:[1,0]
    v_cvt_pk_bf16_f32 v36, v18, v19
    buffer_store_dwordx4 v[32:35], v6, s[20:23], s35 offen
    buffer_store_dword v36, v7, s[20:23], s35 offen offset:1024
    s_endpgm
.globl attn_kernel
.p2align 8
.type attn_kernel,@function
attn_kernel:
    s_load_dwordx2 s[10:11], s[0:1], 80
    v_lshrrev_b32 v2, 6, v0
    v_and_b32 v1, 63, v0
    s_mov_b32 s54, 0x1f800000
    v_readfirstlane_b32 s24, v2
    s_cmp_ge_u32 s2, 256
    s_cbranch_scc1 k2_other
    s_and_b32 s25, s2, 7
    s_lshl_b32 s25, s25, 2
    s_lshr_b32 s26, s2, 6
    s_add_u32 s25, s25, s26
    s_bfe_u32 s26, s2, 0x30003
    s_load_dwordx2 s[4:5], s[0:1], 0
    s_load_dwordx2 s[8:9], s[0:1], 64
    s_lshl_b32 s60, s26, 2
    s_lshr_b32 s61, s25, 3
    s_add_u32 s60, s60, s61
    s_and_b32 s61, s25, 7
    s_mov_b32 s44, 122880
    s_mov_b32 s52, 3932160
    s_mul_i32 s45, s25, 1280
    s_add_u32 s45, s45, 40960
    s_mul_i32 s46, s25, 320
    s_add_u32 s46, s46, 81920
    s_movk_i32 s47, 320
    s_movk_i32 s48, 10240
    v_mul_u32_u24 v120, 3277, v0
    v_lshrrev_b32 v120, 16, v120
    v_mul_u32_u24 v121, 20, v120
    v_sub_u32 v121, v0, v121
    v_lshlrev_b32 v121, 4, v121
    v_bfe_u32 v122, v120, 2, 2
    v_mad_u32_u24 v121, v122, s44, v121
    v_lshrrev_b32 v122, 4, v120
    v_mad_u32_u24 v121, v122, s52, v121
    v_and_b32 v120, 3, v120
    v_mad_u32_u24 v2, v120, s47, v121
    v_mad_u32_u24 v3, v120, s48, v121
    v_add_u32 v2, s45, v2
    v_add_u32 v3, s46, v3
    s_cmp_lt_u32 s24, 2
    s_cselect_b32 s49, s47, s48
    s_cselect_b32 s50, s45, s46
    s_cselect_b32 s39, 8, 16
    s_lshl_b32 s39, s39, 10
    v_and_b32 v123, 127, v0
    v_add_u32 v123, 512, v123
    v_mul_u32_u24 v120, 3277, v123
    v_lshrrev_b32 v120, 16, v120
    v_mul_u32_u24 v121, 20, v120
    v_sub_u32 v121, v123, v121
    v_lshlrev_b32 v121, 4, v121
    v_bfe_u32 v122, v120, 2, 2
    v_mad_u32_u24 v121, v122, s44, v121
    v_lshrrev_b32 v122, 4, v120
    v_mad_u32_u24 v121, v122, s52, v121
    v_and_b32 v120, 3, v120
    v_mad_u32_u24 v4, v120, s49, v121
    v_add_u32 v4, s50, v4
    s_mov_b32 s28, 0
    s_mov_b32 s59, 491520
    s_lshl_b32 s30, s24, 10
    v_lshrrev_b32 v120, 5, v1
    v_and_b32 v121, 31, v1
    s_and_b32 s31, s25, 1
    s_lshl_b32 s33, s31, 8
    v_lshl_add_u32 v5, v1, 4, s33
    s_xor_b32 s31, s31, 1
    s_lshl_b32 s33, s31, 10
    v_lshl_add_u32 v7, v1, 3, s33
    v_lshlrev_b32 v122, 31, v120
    v_or_b32 v122, v122, v7
    s_lshl_b32 s51, s26, 3
    s_and_b32 s31, s24, 3
    s_lshl_b32 s31, s31, 1
    s_add_u32 s51, s51, s31
    s_lshr_b32 s53, s24, 2
    s_add_u32 s51, s51, s53
    s_xor_b32 s37, s51, 1
    s_mul_i32 s31, s51, s44
    s_mul_i32 s37, s37, s44
    s_mul_i32 s29, s25, 1280
    s_add_u32 s31, s31, s29
    s_add_u32 s37, s37, s29
    s_waitcnt lgkmcnt(0)
    s_mov_b32 s20, s10
    s_mov_b32 s21, s11
    s_mov_b32 s22, 11634688
    s_mov_b32 s23, 0x20000
    s_mov_b32 m0, s30
    s_nop 0
    buffer_load_dwordx4 v2, s[20:23], s28 offen lds
    s_addk_i32 m0, 10240
    s_cmp_ge_u32 s24, 4
    buffer_load_dwordx4 v3, s[20:23], s28 offen lds
    s_cbranch_scc1 k2_d0
    s_add_u32 m0, s30, s39
    s_nop 0
    buffer_load_dwordx4 v4, s[20:23], s28 offen lds
k2_d0:
    s_add_u32 s28, s28, s59
    buffer_load_dwordx4 v[8:11], v5, s[20:23], s31 offen
    buffer_load_dwordx2 v[12:13], v122, s[20:23], s31 offen
    buffer_load_dwordx4 v[14:17], v5, s[20:23], s37 offen
    buffer_load_dwordx2 v[18:19], v122, s[20:23], s37 offen
    s_add_u32 s30, s30, 20480
    s_cmp_ge_u32 s24, 6
    s_cselect_b32 s12, s10, s4
    s_cselect_b32 s13, s11, s5
    s_mov_b32 s14, 2621440
    s_cselect_b32 s14, 11634688, s14
    s_cselect_b32 s62, 5, 10
    s_lshl_b32 s62, s62, 7
    s_mov_b32 s15, 0x20000
    s_and_b32 s58, s2, 1
    s_lshr_b32 s63, s2, 3
    s_lshl_b32 s57, s58, 5
    s_add_u32 s57, s57, s63
    s_mul_i32 s57, s57, 12800
    s_add_u32 s57, s57, 10815488
    s_lshl_b32 s31, s60, 2
    s_and_b32 s63, s25, 3
    s_add_u32 s31, s31, s63
    s_mul_i32 s31, s31, 20480
    s_mul_i32 s63, s58, 640
    s_add_u32 s31, s31, s63
    s_cmp_ge_u32 s24, 6
    s_cselect_b32 s57, s57, s31
    s_and_b32 s31, s24, 1
    s_mul_i32 s31, s31, s62
    s_mul_i32 s31, s31, 12
    s_add_u32 s57, s57, s31
    s_sub_u32 s58, 8, s24
    s_min_u32 s58, s58, 5
    v_mul_u32_u24 v124, 13108, v1
    v_lshrrev_b32 v124, 16, v124
    v_mul_u32_u24 v125, 5, v124
    v_sub_u32 v125, v1, v125
    v_mul_u32_u24 v126, s62, v124
    v_lshl_add_u32 v126, v125, 7, v126
    s_and_b32 s38, s24, 3
    s_lshl_b32 s49, s60, 2
    s_add_u32 s49, s49, s38
    s_mul_i32 s37, s49, 20480
    s_mul_i32 s50, s61, 160
    s_add_u32 s37, s37, s50
    s_mul_i32 s48, s53, 96
    s_add_u32 s38, s37, s48
    s_mov_b32 s16, s4
    s_mov_b32 s17, s5
    s_mov_b32 s18, 2621440
    s_mov_b32 s19, 0x20000
    s_lshl_b32 s62, s49, 6
    s_add_u32 s62, s62, 10485760
    s_and_b32 s63, s2, 31
    s_lshl_b32 s63, s63, 7
    s_add_u32 s63, s63, 10721280
    s_mul_i32 s31, s53, 5120
    v_add_u32 v5, s31, v5
    v_add_u32 v7, s31, v7
    v_lshrrev_b32 v123, 1, v121
    v_xor_b32 v123, v123, v121
    v_and_b32 v123, 4, v123
    v_mul_u32_u24 v123, 3, v123
    v_xor_b32 v121, v121, v123
    v_mul_u32_u24 v6, 320, v120
    v_lshl_add_u32 v6, v121, 4, v6
    s_add_u32 s31, s31, 10240
    v_add_u32 v6, s31, v6
    s_mov_b32 s40, 0x000fffff
    s_mov_b32 s41, 0x000fffff
    s_mov_b32 s27, 0
    s_mov_b32 s35, 4294905856
    s_mov_b32 s36, 20480
    s_mov_b32 s33, s36
    s_mov_b32 s34, s35
    s_mul_i32 s56, s53, 7
    s_sub_u32 s55, 7, s56
    s_mov_b32 s42, 0x11000000
    s_mov_b32 s43, 0x11000000
    v_mov_b32 v123, 0x3f803f80
    v_cndmask_b32 v32, 0, v123, s[42:43]
    v_mov_b32 v33, v32
    v_mov_b32 v34, v32
    v_mov_b32 v35, v32
    v_mov_b32 v36, v32
    v_mov_b32 v37, v32
    v_mov_b32 v38, v32
    v_mov_b32 v39, v32
    v_mov_b32 v40, v32
    v_mov_b32 v41, v32
    v_mov_b32 v42, v32
    v_mov_b32 v43, v32
    v_mov_b32 v44, v32
    v_mov_b32 v45, v32
    v_mov_b32 v46, v32
    v_mov_b32 v47, v32
    v_mov_b32 v48, 0
    v_mov_b32 v49, 0
    v_mov_b32 v50, 0
    v_mov_b32 v51, 0
    v_mov_b32 v52, 0
    v_mov_b32 v53, 0
    v_mov_b32 v54, 0
    v_mov_b32 v55, 0
    v_mov_b32 v88, 0
    v_mov_b32 v89, 0
    v_mov_b32 v90, 0
    v_mov_b32 v91, 0
    v_mov_b32 v92, 0
    v_mov_b32 v93, 0
    v_mov_b32 v94, 0
    v_mov_b32 v95, 0
    v_mov_b32 v96, 0
    v_mov_b32 v97, 0
    v_mov_b32 v98, 0
    v_mov_b32 v99, 0
    v_mov_b32 v100, 0
    v_mov_b32 v101, 0
    v_mov_b32 v102, 0
    v_mov_b32 v103, 0
    v_mov_b32 v104, 0
    v_mov_b32 v105, 0
    v_mov_b32 v106, 0
    v_mov_b32 v107, 0
    v_mov_b32 v108, 0
    v_mov_b32 v109, 0
    v_mov_b32 v110, 0
    v_mov_b32 v111, 0
    v_mov_b32 v112, 0
    v_mov_b32 v113, 0
    v_mov_b32 v114, 0
    v_mov_b32 v115, 0
    v_mov_b32 v116, 0
    v_mov_b32 v117, 0
    v_mov_b32 v118, 0
    v_mov_b32 v119, 0
    v_mov_b32 v84, 0
    v_mov_b32 v85, 0
    v_mov_b32 v86, 0
    v_mov_b32 v87, 0
    s_waitcnt vmcnt(0)
    s_barrier
    ds_read_b128 v[20:23], v5
    ds_read_b64 v[24:25], v7
    s_mov_b32 m0, s30
    s_nop 0
    buffer_load_dwordx4 v2, s[20:23], s28 offen lds
    s_addk_i32 m0, 10240
    s_cmp_ge_u32 s24, 4
    buffer_load_dwordx4 v3, s[20:23], s28 offen lds
    s_cbranch_scc1 k2_d1
    s_add_u32 m0, s30, s39
    s_nop 0
    buffer_load_dwordx4 v4, s[20:23], s28 offen lds
k2_d1:
    s_add_u32 s28, s28, s59
    s_add_u32 s30, s30, 20480
    s_waitcnt lgkmcnt(0)
    v_mfma_f32_32x32x16_bf16 v[56:71], v[20:23], v[8:11], 0
    v_mfma_f32_32x32x8_bf16 v[56:71], v[24:25], v[12:13], v[56:71]
    s_mov_b32 m0, s30
    s_nop 0
    buffer_load_dwordx4 v2, s[20:23], s28 offen lds
    s_addk_i32 m0, 10240
    s_cmp_ge_u32 s24, 4
    buffer_load_dwordx4 v3, s[20:23], s28 offen lds
    s_cbranch_scc1 k2_d2
    s_add_u32 m0, s30, s39
    s_nop 0
    buffer_load_dwordx4 v4, s[20:23], s28 offen lds
k2_d2:
    s_add_u32 s28, s28, s59
    s_add_u32 s30, s30, 20480
    s_setprio 3
    s_nop 1
.p2align 6
k2_loop:
    v_exp_f32 v56, v56
    v_exp_f32 v57, v57
    v_mfma_f32_32x32x16_bf16 v[104:119], v[40:43], v[48:51], v[104:119]
    s_mov_b64 exec, s[40:41]
    ds_read_b128 v[32:35], v6 offset:0
    ds_read_b128 v[36:39], v6 offset:640
    s_mov_b64 exec, -1
    v_exp_f32 v58, v58
    v_exp_f32 v59, v59
    v_cvt_pk_bf16_f32 v54, v84, v85
    v_cvt_pk_bf16_f32 v55, v86, v87
    v_exp_f32 v60, v60
    v_exp_f32 v61, v61
    v_mfma_f32_32x32x16_bf16 v[72:87], v[20:23], v[14:17], 0
    ds_read_b128 v[26:29], v5 offset:1280
    v_exp_f32 v62, v62
    v_exp_f32 v63, v63
    v_cvt_pk_bf16_f32 v48, v56, v57
    v_cvt_pk_bf16_f32 v49, v58, v59
    v_exp_f32 v64, v64
    v_exp_f32 v65, v65
    v_mfma_f32_32x32x8_bf16 v[72:87], v[24:25], v[18:19], v[72:87]
    ds_read_b64 v[30:31], v7 offset:1280
    s_setprio 2
    v_exp_f32 v66, v66
    v_exp_f32 v67, v67
    v_cvt_pk_bf16_f32 v50, v60, v61
    v_cvt_pk_bf16_f32 v51, v62, v63
    v_exp_f32 v68, v68
    v_exp_f32 v69, v69
    v_mfma_f32_32x32x16_bf16 v[104:119], v[44:47], v[52:55], v[104:119]
    v_exp_f32 v70, v70
    v_exp_f32 v71, v71
    v_cvt_pk_bf16_f32 v52, v64, v65
    v_cvt_pk_bf16_f32 v53, v66, v67
    v_exp_f32 v72, v72
    v_exp_f32 v73, v73
    s_waitcnt lgkmcnt(0)
    v_mfma_f32_32x32x16_bf16 v[88:103], v[32:35], v[48:51], v[88:103]
    v_exp_f32 v74, v74
    v_exp_f32 v75, v75
    v_cvt_pk_bf16_f32 v54, v68, v69
    v_cvt_pk_bf16_f32 v55, v70, v71
    v_exp_f32 v76, v76
    v_exp_f32 v77, v77
    v_mfma_f32_32x32x16_bf16 v[56:71], v[26:29], v[8:11], 0
    v_exp_f32 v78, v78
    v_exp_f32 v79, v79
    v_cvt_pk_bf16_f32 v48, v72, v73
    v_cvt_pk_bf16_f32 v49, v74, v75
    v_exp_f32 v80, v80
    v_exp_f32 v81, v81
    v_mfma_f32_32x32x8_bf16 v[56:71], v[30:31], v[12:13], v[56:71]
    v_exp_f32 v82, v82
    v_exp_f32 v83, v83
    v_cvt_pk_bf16_f32 v50, v76, v77
    v_cvt_pk_bf16_f32 v51, v78, v79
    v_exp_f32 v84, v84
    v_exp_f32 v85, v85
    v_mfma_f32_32x32x16_bf16 v[88:103], v[36:39], v[52:55], v[88:103]
    s_nop 0
    v_exp_f32 v86, v86
    v_exp_f32 v87, v87
    v_cvt_pk_bf16_f32 v52, v80, v81
    v_cvt_pk_bf16_f32 v53, v82, v83
    v_exp_f32 v56, v56
    v_exp_f32 v57, v57
    v_mfma_f32_32x32x16_bf16 v[104:119], v[32:35], v[48:51], v[104:119]
    s_mov_b64 exec, s[40:41]
    ds_read_b128 v[40:43], v6 offset:1280
    ds_read_b128 v[44:47], v6 offset:1920
    s_mov_b64 exec, -1
    v_exp_f32 v58, v58
    v_exp_f32 v59, v59
    v_cvt_pk_bf16_f32 v54, v84, v85
    v_cvt_pk_bf16_f32 v55, v86, v87
    v_exp_f32 v60, v60
    v_exp_f32 v61, v61
    v_mfma_f32_32x32x16_bf16 v[72:87], v[26:29], v[14:17], 0
    ds_read_b128 v[20:23], v5 offset:2560
    v_exp_f32 v62, v62
    v_exp_f32 v63, v63
    v_cvt_pk_bf16_f32 v48, v56, v57
    v_cvt_pk_bf16_f32 v49, v58, v59
    v_exp_f32 v64, v64
    v_exp_f32 v65, v65
    v_mfma_f32_32x32x8_bf16 v[72:87], v[30:31], v[18:19], v[72:87]
    ds_read_b64 v[24:25], v7 offset:2560
    s_setprio 1
    v_exp_f32 v66, v66
    v_exp_f32 v67, v67
    v_cvt_pk_bf16_f32 v50, v60, v61
    v_cvt_pk_bf16_f32 v51, v62, v63
    v_exp_f32 v68, v68
    v_exp_f32 v69, v69
    v_mfma_f32_32x32x16_bf16 v[104:119], v[36:39], v[52:55], v[104:119]
    v_exp_f32 v70, v70
    v_exp_f32 v71, v71
    v_cvt_pk_bf16_f32 v52, v64, v65
    v_cvt_pk_bf16_f32 v53, v66, v67
    v_exp_f32 v72, v72
    v_exp_f32 v73, v73
    s_waitcnt lgkmcnt(0)
    v_mfma_f32_32x32x16_bf16 v[88:103], v[40:43], v[48:51], v[88:103]
    v_exp_f32 v74, v74
    v_exp_f32 v75, v75
    v_cvt_pk_bf16_f32 v54, v68, v69
    v_cvt_pk_bf16_f32 v55, v70, v71
    v_exp_f32 v76, v76
    v_exp_f32 v77, v77
    v_mfma_f32_32x32x16_bf16 v[56:71], v[20:23], v[8:11], 0
    v_exp_f32 v78, v78
    v_exp_f32 v79, v79
    v_cvt_pk_bf16_f32 v48, v72, v73
    v_cvt_pk_bf16_f32 v49, v74, v75
    v_exp_f32 v80, v80
    v_exp_f32 v81, v81
    v_mfma_f32_32x32x8_bf16 v[56:71], v[24:25], v[12:13], v[56:71]
    v_exp_f32 v82, v82
    v_exp_f32 v83, v83
    v_cvt_pk_bf16_f32 v50, v76, v77
    v_cvt_pk_bf16_f32 v51, v78, v79
    v_exp_f32 v84, v84
    v_exp_f32 v85, v85
    v_mfma_f32_32x32x16_bf16 v[88:103], v[44:47], v[52:55], v[88:103]
    s_nop 0
    v_exp_f32 v86, v86
    v_exp_f32 v87, v87
    v_cvt_pk_bf16_f32 v52, v80, v81
    v_cvt_pk_bf16_f32 v53, v82, v83
    v_exp_f32 v56, v56
    v_exp_f32 v57, v57
    v_mfma_f32_32x32x16_bf16 v[104:119], v[40:43], v[48:51], v[104:119]
    s_mov_b64 exec, s[40:41]
    ds_read_b128 v[32:35], v6 offset:2560
    ds_read_b128 v[36:39], v6 offset:3200
    s_mov_b64 exec, -1
    v_exp_f32 v58, v58
    v_exp_f32 v59, v59
    v_cvt_pk_bf16_f32 v54, v84, v85
    v_cvt_pk_bf16_f32 v55, v86, v87
    v_exp_f32 v60, v60
    v_exp_f32 v61, v61
    v_mfma_f32_32x32x16_bf16 v[72:87], v[20:23], v[14:17], 0
    ds_read_b128 v[26:29], v5 offset:3840
    v_exp_f32 v62, v62
    v_exp_f32 v63, v63
    v_cvt_pk_bf16_f32 v48, v56, v57
    v_cvt_pk_bf16_f32 v49, v58, v59
    v_exp_f32 v64, v64
    v_exp_f32 v65, v65
    v_mfma_f32_32x32x8_bf16 v[72:87], v[24:25], v[18:19], v[72:87]
    ds_read_b64 v[30:31], v7 offset:3840
    s_setprio 0
    v_exp_f32 v66, v66
    v_exp_f32 v67, v67
    v_cvt_pk_bf16_f32 v50, v60, v61
    v_cvt_pk_bf16_f32 v51, v62, v63
    v_exp_f32 v68, v68
    v_exp_f32 v69, v69
    v_mfma_f32_32x32x16_bf16 v[104:119], v[44:47], v[52:55], v[104:119]
    v_exp_f32 v70, v70
    v_exp_f32 v71, v71
    v_cvt_pk_bf16_f32 v52, v64, v65
    v_cvt_pk_bf16_f32 v53, v66, v67
    v_exp_f32 v72, v72
    v_exp_f32 v73, v73
    s_waitcnt lgkmcnt(0)
    v_mfma_f32_32x32x16_bf16 v[88:103], v[32:35], v[48:51], v[88:103]
    s_waitcnt vmcnt(2)
    s_barrier
    s_setprio 3
    v_exp_f32 v74, v74
    v_exp_f32 v75, v75
    v_cvt_pk_bf16_f32 v54, v68, v69
    v_cvt_pk_bf16_f32 v55, v70, v71
    v_exp_f32 v76, v76
    v_exp_f32 v77, v77
    v_mfma_f32_32x32x16_bf16 v[56:71], v[26:29], v[8:11], 0
    s_cmp_ge_u32 s27, s55
    s_cbranch_scc1 k2_dla_skip
    s_mov_b32 m0, s30
    s_nop 0
    buffer_load_dwordx4 v2, s[20:23], s28 offen lds
    s_addk_i32 m0, 10240
    s_cmp_ge_u32 s24, 4
    buffer_load_dwordx4 v3, s[20:23], s28 offen lds
    s_cbranch_scc1 k2_dla
    s_add_u32 m0, s30, s39
    s_nop 0
    buffer_load_dwordx4 v4, s[20:23], s28 offen lds
k2_dla:
    s_add_u32 s28, s28, s59
    s_add_u32 s30, s30, s34
k2_dla_skip:
    v_exp_f32 v78, v78
    v_exp_f32 v79, v79
    v_cvt_pk_bf16_f32 v48, v72, v73
    v_cvt_pk_bf16_f32 v49, v74, v75
    v_exp_f32 v80, v80
    v_exp_f32 v81, v81
    v_mfma_f32_32x32x8_bf16 v[56:71], v[30:31], v[12:13], v[56:71]
    v_add_u32 v5, s33, v5
    v_add_u32 v7, s33, v7
    v_exp_f32 v82, v82
    v_exp_f32 v83, v83
    v_cvt_pk_bf16_f32 v50, v76, v77
    v_cvt_pk_bf16_f32 v51, v78, v79
    v_exp_f32 v84, v84
    v_exp_f32 v85, v85
    v_mfma_f32_32x32x16_bf16 v[88:103], v[36:39], v[52:55], v[88:103]
    v_exp_f32 v86, v86
    v_exp_f32 v87, v87
    v_cvt_pk_bf16_f32 v52, v80, v81
    v_cvt_pk_bf16_f32 v53, v82, v83
    v_exp_f32 v56, v56
    v_exp_f32 v57, v57
    v_mfma_f32_32x32x16_bf16 v[104:119], v[32:35], v[48:51], v[104:119]
    s_mov_b64 exec, s[40:41]
    ds_read_b128 v[40:43], v6 offset:3840
    ds_read_b128 v[44:47], v6 offset:4480
    s_mov_b64 exec, -1
    v_exp_f32 v58, v58
    v_exp_f32 v59, v59
    v_cvt_pk_bf16_f32 v54, v84, v85
    v_cvt_pk_bf16_f32 v55, v86, v87
    v_exp_f32 v60, v60
    v_exp_f32 v61, v61
    v_mfma_f32_32x32x16_bf16 v[72:87], v[26:29], v[14:17], 0
    ds_read_b128 v[20:23], v5 offset:0
    v_exp_f32 v62, v62
    v_exp_f32 v63, v63
    v_cvt_pk_bf16_f32 v48, v56, v57
    v_cvt_pk_bf16_f32 v49, v58, v59
    v_exp_f32 v64, v64
    v_exp_f32 v65, v65
    v_mfma_f32_32x32x8_bf16 v[72:87], v[30:31], v[18:19], v[72:87]
    ds_read_b64 v[24:25], v7 offset:0
    v_exp_f32 v66, v66
    v_exp_f32 v67, v67
    v_cvt_pk_bf16_f32 v50, v60, v61
    v_cvt_pk_bf16_f32 v51, v62, v63
    v_exp_f32 v68, v68
    v_exp_f32 v69, v69
    v_mfma_f32_32x32x16_bf16 v[104:119], v[36:39], v[52:55], v[104:119]
    v_exp_f32 v70, v70
    v_exp_f32 v71, v71
    v_cvt_pk_bf16_f32 v52, v64, v65
    v_cvt_pk_bf16_f32 v53, v66, v67
    v_exp_f32 v72, v72
    v_exp_f32 v73, v73
    s_waitcnt lgkmcnt(0)
    v_mfma_f32_32x32x16_bf16 v[88:103], v[40:43], v[48:51], v[88:103]
    s_cmp_ge_u32 s27, s56
    s_cbranch_scc1 k2_dlb_skip
    s_mov_b32 m0, s30
    s_nop 0
    buffer_load_dwordx4 v2, s[20:23], s28 offen lds
    s_addk_i32 m0, 10240
    s_cmp_ge_u32 s24, 4
    buffer_load_dwordx4 v3, s[20:23], s28 offen lds
    s_cbranch_scc1 k2_dlb
    s_add_u32 m0, s30, s39
    s_nop 0
    buffer_load_dwordx4 v4, s[20:23], s28 offen lds
k2_dlb:
    s_add_u32 s28, s28, s59
    s_add_u32 s30, s30, s34
k2_dlb_skip:
    v_exp_f32 v74, v74
    v_exp_f32 v75, v75
    v_cvt_pk_bf16_f32 v54, v68, v69
    v_cvt_pk_bf16_f32 v55, v70, v71
    v_exp_f32 v76, v76
    v_exp_f32 v77, v77
    v_mfma_f32_32x32x16_bf16 v[56:71], v[20:23], v[8:11], 0
    v_add_u32 v6, s33, v6
    s_mov_b32 s34, s33
    s_add_u32 s27, s27, 1
    v_exp_f32 v78, v78
    v_exp_f32 v79, v79
    v_cvt_pk_bf16_f32 v48, v72, v73
    v_cvt_pk_bf16_f32 v49, v74, v75
    v_exp_f32 v80, v80
    v_exp_f32 v81, v81
    v_mfma_f32_32x32x8_bf16 v[56:71], v[24:25], v[12:13], v[56:71]
    s_and_b32 s32, s27, 3
    s_cmp_eq_u32 s32, 3
    s_cselect_b32 s33, s35, s36
    v_exp_f32 v82, v82
    v_exp_f32 v83, v83
    v_cvt_pk_bf16_f32 v50, v76, v77
    v_cvt_pk_bf16_f32 v51, v78, v79
    v_exp_f32 v84, v84
    v_exp_f32 v85, v85
    v_mfma_f32_32x32x16_bf16 v[88:103], v[44:47], v[52:55], v[88:103]
    s_cmp_ge_u32 s27, s58
    s_cbranch_scc1 k2_hook
k2_nl:
    v_exp_f32 v86, v86
    v_exp_f32 v87, v87
    v_cvt_pk_bf16_f32 v52, v80, v81
    v_cvt_pk_bf16_f32 v53, v82, v83
    s_cmp_lt_u32 s27, 8
    s_cbranch_scc1 k2_loop
    s_setprio 0
    v_mfma_f32_32x32x16_bf16 v[104:119], v[40:43], v[48:51], v[104:119]
    v_cvt_pk_bf16_f32 v54, v84, v85
    v_cvt_pk_bf16_f32 v55, v86, v87
    s_mul_i32 s31, s24, 3328
    s_xor_b32 s33, s24, 4
    v_mfma_f32_32x32x16_bf16 v[104:119], v[44:47], v[52:55], v[104:119]
    s_mul_i32 s33, s33, 3328
    s_add_u32 s31, s31, 40960
    s_add_u32 s33, s33, 40960
    v_lshl_add_u32 v26, v1, 4, s31
    v_lshl_add_u32 v27, v1, 2, s31
    v_lshl_add_u32 v28, v1, 4, s33
    v_lshl_add_u32 v29, v1, 2, s33
    s_mul_i32 s29, s51, 40960
    s_add_u32 s29, s29, 7864320
    s_lshr_b32 s31, s25, 1
    s_lshl_b32 s31, s31, 9
    s_add_u32 s30, s29, s31
    ds_write_b128 v26, v[104:107] offset:0
    ds_write_b128 v26, v[108:111] offset:1024
    ds_write_b128 v26, v[112:115] offset:2048
    ds_write_b32 v27, v116 offset:3072
    s_and_b32 s31, s25, 1
    s_lshl_b32 s31, s31, 3
    s_add_u32 s30, s30, s31
    s_add_u32 s30, s30, 32768
    s_lshl_b32 s31, s25, 10
    s_add_u32 s29, s29, s31
    s_waitcnt vmcnt(0)
    v_cmp_eq_u32 vcc, 0, v127
    s_cbranch_vccnz pj_nokey
pj_sel:
    s_sub_u32 s31, 127, s49
    v_bfe_u32 v30, v127, 7, 7
    v_cmp_eq_u32 vcc, s31, v30
    s_and_b32 s47, vcc_lo, 0xff
    s_cbranch_scc0 pj_nh
    v_mov_b32 v30, 10725376
    global_load_dword v31, v30, s[10:11] sc1
pj_nh:
    s_waitcnt lgkmcnt(0)
    s_barrier
    ds_read_b128 v[56:59], v28 offset:0
    ds_read_b128 v[60:63], v28 offset:1024
    ds_read_b128 v[64:67], v28 offset:2048
    ds_read_b32 v68, v29 offset:3072
    v_lshlrev_b32 v2, 4, v1
    v_mov_b32 v7, 0x5f800000
    s_waitcnt lgkmcnt(0)
    v_add_f32 v100, v100, v68
    v_pk_add_f32 v[88:89], v[88:89], v[56:57]
    v_pk_add_f32 v[90:91], v[90:91], v[58:59]
    v_pk_add_f32 v[92:93], v[92:93], v[60:61]
    v_pk_add_f32 v[94:95], v[94:95], v[62:63]
    v_pk_add_f32 v[96:97], v[96:97], v[64:65]
    v_pk_add_f32 v[98:99], v[98:99], v[66:67]
    v_med3_f32 v3, v100, v7, s54
    v_cmp_neq_f32 vcc, v100, v3
    s_cbranch_vccnz k2_slow
k2_fin:
    v_rcp_f32 v4, v100
    s_nop 0
    v_pk_mul_f32 v[88:89], v[88:89], v[4:5] op_sel_hi:[1,0]
    v_pk_mul_f32 v[90:91], v[90:91], v[4:5] op_sel_hi:[1,0]
    v_pk_mul_f32 v[92:93], v[92:93], v[4:5] op_sel_hi:[1,0]
    v_pk_mul_f32 v[94:95], v[94:95], v[4:5] op_sel_hi:[1,0]
    v_pk_mul_f32 v[96:97], v[96:97], v[4:5] op_sel_hi:[1,0]
    v_pk_mul_f32 v[98:99], v[98:99], v[4:5] op_sel_hi:[1,0]
    v_cvt_pk_bf16_f32 v88, v88, v89
    v_cvt_pk_bf16_f32 v89, v90, v91
    v_cvt_pk_bf16_f32 v90, v92, v93
    v_cvt_pk_bf16_f32 v91, v94, v95
    v_cvt_pk_bf16_f32 v92, v96, v97
    v_cvt_pk_bf16_f32 v93, v98, v99
    buffer_store_dwordx4 v[88:91], v2, s[20:23], s29 offen sc1
    s_mov_b32 exec_hi, 0
    buffer_store_dwordx2 v[92:93], v2, s[20:23], s30 offen sc1
    s_mov_b64 exec, -1
    v_lshrrev_b32 v7, 4, v1
    v_mov_b32 v3, v126
    s_mov_b32 s41, s47
    s_and_b32 s46, s47, s47
    s_cbranch_scc1 pj_hit0
pj_ret0:
    v_lshrrev_b32 v5, 2, v1
    v_mul_u32_u24 v5, 160, v5
    v_and_b32 v4, 3, v1
    v_lshl_add_u32 v5, v4, 3, v5
    s_mul_i32 s31, s53, 5120
    v_add_u32 v5, s31, v5
    v_add_u32 v4, s48, v5
    s_sub_u32 s31, 96, s48
    v_add_u32 v6, s31, v5
    v_add_u32 v5, 64, v5
    ds_read_b64_tr_b16 v[8:9], v4 offset:0
    ds_read_b64_tr_b16 v[10:11], v4 offset:2560
    ds_read_b64_tr_b16 v[12:13], v4 offset:32
    ds_read_b64_tr_b16 v[14:15], v4 offset:2592
    ds_read_b64_tr_b16 v[16:17], v5 offset:0
    ds_read_b64_tr_b16 v[18:19], v5 offset:2560
    ds_read_b64_tr_b16 v[20:21], v6 offset:0
    ds_read_b64_tr_b16 v[22:23], v6 offset:2560
    ds_read_b64_tr_b16 v[24:25], v6 offset:32
    ds_read_b64_tr_b16 v[26:27], v6 offset:2592
    s_mov_b32 s12, s8
    s_mov_b32 s13, s9
    s_mov_b32 s14, 2621440
    s_mov_b32 s15, 0x20000
    v_and_b32 v48, 0xffff0000, v0
    v_rcp_f32 v48, v48
    v_lshlrev_b32 v49, 16, v0
    v_and_b32 v0, 15, v1
    v_mul_f32 v108, v48, -v49
    s_waitcnt lgkmcnt(4)
    ds_read_b64_tr_b16 v[28:29], v4 offset:10240
    ds_read_b64_tr_b16 v[30:31], v4 offset:12800
    ds_read_b64_tr_b16 v[32:33], v4 offset:10272
    ds_read_b64_tr_b16 v[34:35], v4 offset:12832
    ds_read_b64_tr_b16 v[36:37], v5 offset:10240
    ds_read_b64_tr_b16 v[38:39], v5 offset:12800
    ds_read_b64_tr_b16 v[40:41], v6 offset:10240
    ds_read_b64_tr_b16 v[42:43], v6 offset:12800
    ds_read_b64_tr_b16 v[44:45], v6 offset:10272
    ds_read_b64_tr_b16 v[46:47], v6 offset:12832
    v_mov_b32 v109, v108
    v_mov_b32 v110, v108
    v_mov_b32 v111, v108
    v_mov_b32 v112, v108
    v_mov_b32 v113, v108
    v_mov_b32 v114, v108
    v_mov_b32 v115, v108
    v_mov_b32 v116, v108
    v_mov_b32 v117, v108
    v_mov_b32 v118, v108
    v_mov_b32 v119, v108
    v_mov_b32 v52, 0xbfb8aa3b
    s_lshl_b32 s30, s24, 10
    s_mul_i32 s28, s61, 102400
    s_add_u32 s28, s28, s30
    s_add_u32 s28, s28, 10856448
    s_add_u32 m0, s30, 40960
    s_waitcnt lgkmcnt(0)
    s_barrier
    buffer_load_dwordx4 v2, s[20:23], s28 offen lds
    s_addk_i32 m0, 0x2000
    s_addk_i32 s28, 0x2000
    buffer_load_dwordx4 v2, s[20:23], s28 offen lds
    s_addk_i32 m0, 0x2000
    s_addk_i32 s28, 0x2000
    buffer_load_dwordx4 v2, s[20:23], s28 offen lds
    s_addk_i32 m0, 0x2000
    s_addk_i32 s28, 0x2000
    buffer_load_dwordx4 v2, s[20:23], s28 offen lds
    s_addk_i32 m0, 0x2000
    s_addk_i32 s28, 0x2000
    s_cmp_lg_u32 s46, 0
    s_cbranch_scc1 pj_ret1
pj_gate:
    v_lshlrev_b32 v76, 16, v120
    v_lshlrev_b32 v78, 16, v121
    v_and_b32 v77, 0xffff0000, v120
    v_and_b32 v79, 0xffff0000, v121
    v_pk_fma_f32 v[108:109], v[76:77], v[48:49], v[108:109] op_sel_hi:[1,0,1]
    v_pk_fma_f32 v[110:111], v[78:79], v[48:49], v[110:111] op_sel_hi:[1,0,1]
    v_pk_mul_f32 v[76:77], v[108:109], v[52:53] op_sel_hi:[1,0]
    v_pk_mul_f32 v[78:79], v[110:111], v[52:53] op_sel_hi:[1,0]
    v_exp_f32 v76, v76
    v_exp_f32 v78, v78
    v_exp_f32 v77, v77
    v_exp_f32 v79, v79
    v_pk_add_f32 v[76:77], v[76:77], 1.0 op_sel_hi:[1,0]
    v_pk_add_f32 v[78:79], v[78:79], 1.0 op_sel_hi:[1,0]
    v_rcp_f32 v76, v76
    v_rcp_f32 v78, v78
    v_rcp_f32 v77, v77
    v_rcp_f32 v79, v79
    v_pk_mul_f32 v[108:109], v[108:109], v[76:77]
    v_pk_mul_f32 v[110:111], v[110:111], v[78:79]
    v_lshlrev_b32 v76, 16, v122
    v_lshlrev_b32 v78, 16, v123
    v_and_b32 v77, 0xffff0000, v122
    v_and_b32 v79, 0xffff0000, v123
    v_pk_fma_f32 v[112:113], v[76:77], v[48:49], v[112:113] op_sel_hi:[1,0,1]
    v_pk_fma_f32 v[114:115], v[78:79], v[48:49], v[114:115] op_sel_hi:[1,0,1]
    v_pk_mul_f32 v[76:77], v[112:113], v[52:53] op_sel_hi:[1,0]
    v_pk_mul_f32 v[78:79], v[114:115], v[52:53] op_sel_hi:[1,0]
    v_exp_f32 v76, v76
    v_exp_f32 v78, v78
    v_exp_f32 v77, v77
    v_exp_f32 v79, v79
    v_pk_add_f32 v[76:77], v[76:77], 1.0 op_sel_hi:[1,0]
    v_pk_add_f32 v[78:79], v[78:79], 1.0 op_sel_hi:[1,0]
    v_rcp_f32 v76, v76
    v_rcp_f32 v78, v78
    v_rcp_f32 v77, v77
    v_rcp_f32 v79, v79
    v_pk_mul_f32 v[112:113], v[112:113], v[76:77]
    v_pk_mul_f32 v[114:115], v[114:115], v[78:79]
    v_lshlrev_b32 v76, 16, v124
    v_lshlrev_b32 v78, 16, v125
    v_and_b32 v77, 0xffff0000, v124
    v_and_b32 v79, 0xffff0000, v125
    v_pk_fma_f32 v[116:117], v[76:77], v[48:49], v[116:117] op_sel_hi:[1,0,1]
    v_pk_fma_f32 v[118:119], v[78:79], v[48:49], v[118:119] op_sel_hi:[1,0,1]
    v_pk_mul_f32 v[76:77], v[116:117], v[52:53] op_sel_hi:[1,0]
    v_pk_mul_f32 v[78:79], v[118:119], v[52:53] op_sel_hi:[1,0]
    v_exp_f32 v76, v76
    v_exp_f32 v78, v78
    v_exp_f32 v77, v77
    v_exp_f32 v79, v79
    v_pk_add_f32 v[76:77], v[76:77], 1.0 op_sel_hi:[1,0]
    v_pk_add_f32 v[78:79], v[78:79], 1.0 op_sel_hi:[1,0]
    v_rcp_f32 v76, v76
    v_rcp_f32 v78, v78
    v_rcp_f32 v77, v77
    v_rcp_f32 v79, v79
    v_pk_mul_f32 v[116:117], v[116:117], v[76:77]
    v_pk_mul_f32 v[118:119], v[118:119], v[78:79]
    s_cmp_lg_u32 s46, 0
    s_cbranch_scc1 pj_ret2
pj_ret1:
    s_lshl_b32 s31, s26, 8
    s_add_u32 s31, s31, 10717184
    v_mov_b32 v50, s31
    v_mov_b32 v51, 1
    s_waitcnt vmcnt(4)
    s_barrier
    s_cmp_lg_u32 s24, 7
    s_cbranch_scc1 pj_nosig
    s_mov_b64 exec, 1
    global_atomic_add v54, v50, v51, s[10:11] sc0
    s_mov_b64 exec, -1
pj_nosig:
    buffer_load_dwordx4 v2, s[20:23], s28 offen lds
    s_mov_b32 m0, s30
    s_addk_i32 s28, 0x2000
    buffer_load_dwordx4 v2, s[20:23], s28 offen lds
    s_addk_i32 m0, 0x2000
    s_addk_i32 s28, 0x2000
    buffer_load_dwordx4 v2, s[20:23], s28 offen lds
    s_addk_i32 m0, 0x2000
    s_addk_i32 s28, 0x2000
    s_cmp_ge_u32 s24, 4
    s_cbranch_scc1 pj_noc
    buffer_load_dwordx4 v2, s[20:23], s28 offen lds
pj_noc:
    s_cmp_ge_u32 s24, 5
    s_cbranch_scc1 pj_nsp
    s_mul_i32 s31, s60, 81920
    s_lshl_b32 s33, s24, 14
    s_add_u32 s31, s31, s33
    s_add_u32 s31, s31, 7864320
    v_lshlrev_b32 v74, 7, v1
    buffer_load_dword v75, v74, s[20:23], s31 offen sc1
    s_addk_i32 s31, 0x2000
    buffer_load_dword v75, v74, s[20:23], s31 offen sc1
pj_nsp:
    s_cmp_lg_u32 s46, 0
    s_cbranch_scc1 pj_hit
pj_ret2:
    v_lshlrev_b32 v2, 9, v7
    v_lshl_add_u32 v2, v0, 4, v2
    s_lshr_b32 s29, s49, 1
    s_mul_i32 s29, s29, 40960
    s_and_b32 s31, s49, 1
    s_lshl_b32 s31, s31, 8
    s_add_u32 s29, s29, s31
    s_add_u32 s29, s29, 7864320
    s_lshl_b32 s28, s53, 11
    s_add_u32 s28, s28, s29
    s_waitcnt vmcnt(2)
    s_cmp_lt_u32 s24, 5
    s_cbranch_scc1 pj_wait
    s_waitcnt vmcnt(0)
    s_cmp_lg_u32 s24, 7
    s_cbranch_scc1 pj_wait
    v_readfirstlane_b32 s31, v54
    s_cmp_eq_u32 s31, 31
    s_cbranch_scc1 pj_wait
    global_load_dword v54, v50, s[10:11] sc1
    s_mov_b32 s27, 0
pj_grp:
    s_waitcnt vmcnt(0)
    v_readfirstlane_b32 s31, v54
    s_add_u32 s27, s27, 1
    s_cmp_ge_u32 s31, 32
    s_cbranch_scc1 pj_grp_ok
    s_cmp_ge_u32 s27, 0x20000
    s_cbranch_scc1 pj_grp_ok
    s_sleep 1
    global_load_dword v54, v50, s[10:11] sc1
    s_branch pj_grp
pj_grp_ok:
pj_wait:
    s_barrier
    buffer_load_dwordx4 v[68:71], v2, s[20:23], s28 offen sc1
    s_addk_i32 s28, 0x1000
    buffer_load_dwordx4 v[72:75], v2, s[20:23], s28 offen sc1
    s_addk_i32 s28, 0x1000
    buffer_load_dwordx4 v[76:79], v2, s[20:23], s28 offen sc1
    s_addk_i32 s28, 0x1000
    buffer_load_dwordx4 v[80:83], v2, s[20:23], s28 offen sc1
    s_addk_i32 s28, 0x1000
    s_mul_i32 s31, s24, 3072
    s_add_u32 s31, s31, 20480
    v_lshl_add_u32 v126, v1, 4, s31
    s_xor_b32 s31, s24, 4
    s_mul_i32 s31, s31, 3072
    s_add_u32 s31, s31, 20480
    v_lshl_add_u32 v127, v1, 4, s31
    buffer_load_dwordx4 v[84:87], v2, s[20:23], s28 offen sc1
    s_addk_i32 s28, 0x1000
    s_waitcnt vmcnt(4)
    v_mfma_f32_16x16x32_bf16 v[48:51], v[8:11], v[68:71], 0
    ds_read_b64_tr_b16 v[8:9], v4 offset:20480
    ds_read_b64_tr_b16 v[10:11], v4 offset:23040
    v_mfma_f32_16x16x32_bf16 v[52:55], v[12:15], v[68:71], 0
    ds_read_b64_tr_b16 v[12:13], v4 offset:20512
    ds_read_b64_tr_b16 v[14:15], v4 offset:23072
    v_mfma_f32_16x16x32_bf16 v[56:59], v[16:19], v[68:71], 0
    ds_read_b64_tr_b16 v[16:17], v5 offset:20480
    ds_read_b64_tr_b16 v[18:19], v5 offset:23040
    v_mfma_f32_16x16x32_bf16 v[60:63], v[20:23], v[68:71], 0
    ds_read_b64_tr_b16 v[20:21], v6 offset:20480
    ds_read_b64_tr_b16 v[22:23], v6 offset:23040
    v_mfma_f32_16x16x32_bf16 v[64:67], v[24:27], v[68:71], 0
    ds_read_b64_tr_b16 v[24:25], v6 offset:20512
    ds_read_b64_tr_b16 v[26:27], v6 offset:23072
    buffer_load_dwordx4 v[88:91], v2, s[20:23], s28 offen sc1
    s_addk_i32 s28, 0x1000
    s_waitcnt vmcnt(4)
    s_waitcnt lgkmcnt(12)
    v_mfma_f32_16x16x32_bf16 v[48:51], v[28:31], v[72:75], v[48:51]
    ds_read_b64_tr_b16 v[28:29], v4 offset:30720
    ds_read_b64_tr_b16 v[30:31], v4 offset:33280
    s_waitcnt lgkmcnt(12)
    v_mfma_f32_16x16x32_bf16 v[52:55], v[32:35], v[72:75], v[52:55]
    ds_read_b64_tr_b16 v[32:33], v4 offset:30752
    ds_read_b64_tr_b16 v[34:35], v4 offset:33312
    s_waitcnt lgkmcnt(12)
    v_mfma_f32_16x16x32_bf16 v[56:59], v[36:39], v[72:75], v[56:59]
    ds_read_b64_tr_b16 v[36:37], v5 offset:30720
    ds_read_b64_tr_b16 v[38:39], v5 offset:33280
    s_waitcnt lgkmcnt(12)
    v_mfma_f32_16x16x32_bf16 v[60:63], v[40:43], v[72:75], v[60:63]
    ds_read_b64_tr_b16 v[40:41], v6 offset:30720
    ds_read_b64_tr_b16 v[42:43], v6 offset:33280
    s_waitcnt lgkmcnt(12)
    v_mfma_f32_16x16x32_bf16 v[64:67], v[44:47], v[72:75], v[64:67]
    ds_read_b64_tr_b16 v[44:45], v6 offset:30752
    ds_read_b64_tr_b16 v[46:47], v6 offset:33312
    v_add_u32 v4, 40960, v4
    v_add_u32 v5, 40960, v5
    v_add_u32 v6, 40960, v6
    buffer_load_dwordx4 v[92:95], v2, s[20:23], s28 offen sc1
    s_addk_i32 s28, 0x1000
    s_waitcnt vmcnt(4)
    s_waitcnt lgkmcnt(12)
    v_mfma_f32_16x16x32_bf16 v[48:51], v[8:11], v[76:79], v[48:51]
    ds_read_b64_tr_b16 v[8:9], v4 offset:0
    ds_read_b64_tr_b16 v[10:11], v4 offset:2560
    s_waitcnt lgkmcnt(12)
    v_mfma_f32_16x16x32_bf16 v[52:55], v[12:15], v[76:79], v[52:55]
    ds_read_b64_tr_b16 v[12:13], v4 offset:32
    ds_read_b64_tr_b16 v[14:15], v4 offset:2592
    s_waitcnt lgkmcnt(12)
    v_mfma_f32_16x16x32_bf16 v[56:59], v[16:19], v[76:79], v[56:59]
    ds_read_b64_tr_b16 v[16:17], v5 offset:0
    ds_read_b64_tr_b16 v[18:19], v5 offset:2560
    s_waitcnt lgkmcnt(12)
    v_mfma_f32_16x16x32_bf16 v[60:63], v[20:23], v[76:79], v[60:63]
    ds_read_b64_tr_b16 v[20:21], v6 offset:0
    ds_read_b64_tr_b16 v[22:23], v6 offset:2560
    s_waitcnt lgkmcnt(12)
    v_mfma_f32_16x16x32_bf16 v[64:67], v[24:27], v[76:79], v[64:67]
    ds_read_b64_tr_b16 v[24:25], v6 offset:32
    ds_read_b64_tr_b16 v[26:27], v6 offset:2592
    buffer_load_dwordx4 v[96:99], v2, s[20:23], s28 offen sc1
    s_addk_i32 s28, 0x1000
    s_waitcnt vmcnt(4)
    s_waitcnt lgkmcnt(12)
    v_mfma_f32_16x16x32_bf16 v[48:51], v[28:31], v[80:83], v[48:51]
    ds_read_b64_tr_b16 v[28:29], v4 offset:10240
    ds_read_b64_tr_b16 v[30:31], v4 offset:12800
    s_waitcnt lgkmcnt(12)
    v_mfma_f32_16x16x32_bf16 v[52:55], v[32:35], v[80:83], v[52:55]
    ds_read_b64_tr_b16 v[32:33], v4 offset:10272
    ds_read_b64_tr_b16 v[34:35], v4 offset:12832
    s_waitcnt lgkmcnt(12)
    v_mfma_f32_16x16x32_bf16 v[56:59], v[36:39], v[80:83], v[56:59]
    ds_read_b64_tr_b16 v[36:37], v5 offset:10240
    ds_read_b64_tr_b16 v[38:39], v5 offset:12800
    s_waitcnt lgkmcnt(12)
    v_mfma_f32_16x16x32_bf16 v[60:63], v[40:43], v[80:83], v[60:63]
    ds_read_b64_tr_b16 v[40:41], v6 offset:10240
    ds_read_b64_tr_b16 v[42:43], v6 offset:12800
    s_waitcnt lgkmcnt(12)
    v_mfma_f32_16x16x32_bf16 v[64:67], v[44:47], v[80:83], v[64:67]
    ds_read_b64_tr_b16 v[44:45], v6 offset:10272
    ds_read_b64_tr_b16 v[46:47], v6 offset:12832
    buffer_load_dwordx4 v[100:103], v2, s[20:23], s28 offen sc1
    s_addk_i32 s28, 0x1000
    s_waitcnt vmcnt(4)
    s_waitcnt lgkmcnt(12)
    v_mfma_f32_16x16x32_bf16 v[48:51], v[8:11], v[84:87], v[48:51]
    ds_read_b64_tr_b16 v[8:9], v4 offset:20480
    ds_read_b64_tr_b16 v[10:11], v4 offset:23040
    s_waitcnt lgkmcnt(12)
    v_mfma_f32_16x16x32_bf16 v[52:55], v[12:15], v[84:87], v[52:55]
    ds_read_b64_tr_b16 v[12:13], v4 offset:20512
    ds_read_b64_tr_b16 v[14:15], v4 offset:23072
    s_waitcnt lgkmcnt(12)
    v_mfma_f32_16x16x32_bf16 v[56:59], v[16:19], v[84:87], v[56:59]
    ds_read_b64_tr_b16 v[16:17], v5 offset:20480
    ds_read_b64_tr_b16 v[18:19], v5 offset:23040
    s_waitcnt lgkmcnt(12)
    v_mfma_f32_16x16x32_bf16 v[60:63], v[20:23], v[84:87], v[60:63]
    ds_read_b64_tr_b16 v[20:21], v6 offset:20480
    ds_read_b64_tr_b16 v[22:23], v6 offset:23040
    s_waitcnt lgkmcnt(12)
    v_mfma_f32_16x16x32_bf16 v[64:67], v[24:27], v[84:87], v[64:67]
    ds_read_b64_tr_b16 v[24:25], v6 offset:20512
    ds_read_b64_tr_b16 v[26:27], v6 offset:23072
    buffer_load_dwordx4 v[104:107], v2, s[20:23], s28 offen sc1
    s_waitcnt vmcnt(4)
    s_waitcnt lgkmcnt(12)
    v_mfma_f32_16x16x32_bf16 v[48:51], v[28:31], v[88:91], v[48:51]
    ds_read_b64_tr_b16 v[28:29], v4 offset:30720
    ds_read_b64_tr_b16 v[30:31], v4 offset:33280
    s_waitcnt lgkmcnt(12)
    v_mfma_f32_16x16x32_bf16 v[52:55], v[32:35], v[88:91], v[52:55]
    ds_read_b64_tr_b16 v[32:33], v4 offset:30752
    ds_read_b64_tr_b16 v[34:35], v4 offset:33312
    s_waitcnt lgkmcnt(12)
    v_mfma_f32_16x16x32_bf16 v[56:59], v[36:39], v[88:91], v[56:59]
    ds_read_b64_tr_b16 v[36:37], v5 offset:30720
    ds_read_b64_tr_b16 v[38:39], v5 offset:33280
    s_waitcnt lgkmcnt(12)
    v_mfma_f32_16x16x32_bf16 v[60:63], v[40:43], v[88:91], v[60:63]
    ds_read_b64_tr_b16 v[40:41], v6 offset:30720
    ds_read_b64_tr_b16 v[42:43], v6 offset:33280
    s_waitcnt lgkmcnt(12)
    v_mfma_f32_16x16x32_bf16 v[64:67], v[44:47], v[88:91], v[64:67]
    ds_read_b64_tr_b16 v[44:45], v6 offset:30752
    ds_read_b64_tr_b16 v[46:47], v6 offset:33312
    v_add_u32 v4, 4294926336, v4
    v_add_u32 v5, 4294926336, v5
    v_add_u32 v6, 4294926336, v6
    s_waitcnt vmcnt(3)
    s_waitcnt lgkmcnt(12)
    v_mfma_f32_16x16x32_bf16 v[48:51], v[8:11], v[92:95], v[48:51]
    ds_read_b64_tr_b16 v[8:9], v4 offset:0
    ds_read_b64_tr_b16 v[10:11], v4 offset:2560
    s_waitcnt lgkmcnt(12)
    v_mfma_f32_16x16x32_bf16 v[52:55], v[12:15], v[92:95], v[52:55]
    ds_read_b64_tr_b16 v[12:13], v4 offset:32
    ds_read_b64_tr_b16 v[14:15], v4 offset:2592
    s_waitcnt lgkmcnt(12)
    v_mfma_f32_16x16x32_bf16 v[56:59], v[16:19], v[92:95], v[56:59]
    ds_read_b64_tr_b16 v[16:17], v5 offset:0
    ds_read_b64_tr_b16 v[18:19], v5 offset:2560
    s_waitcnt lgkmcnt(12)
    v_mfma_f32_16x16x32_bf16 v[60:63], v[20:23], v[92:95], v[60:63]
    ds_read_b64_tr_b16 v[20:21], v6 offset:0
    ds_read_b64_tr_b16 v[22:23], v6 offset:2560
    s_waitcnt lgkmcnt(12)
    v_mfma_f32_16x16x32_bf16 v[64:67], v[24:27], v[92:95], v[64:67]
    ds_read_b64_tr_b16 v[24:25], v6 offset:32
    ds_read_b64_tr_b16 v[26:27], v6 offset:2592
    s_waitcnt vmcnt(2)
    s_waitcnt lgkmcnt(12)
    v_mfma_f32_16x16x32_bf16 v[48:51], v[28:31], v[96:99], v[48:51]
    ds_read_b64_tr_b16 v[28:29], v4 offset:10240
    ds_read_b64_tr_b16 v[30:31], v4 offset:12800
    s_waitcnt lgkmcnt(12)
    v_mfma_f32_16x16x32_bf16 v[52:55], v[32:35], v[96:99], v[52:55]
    ds_read_b64_tr_b16 v[32:33], v4 offset:10272
    ds_read_b64_tr_b16 v[34:35], v4 offset:12832
    s_waitcnt lgkmcnt(12)
    v_mfma_f32_16x16x32_bf16 v[56:59], v[36:39], v[96:99], v[56:59]
    ds_read_b64_tr_b16 v[36:37], v5 offset:10240
    ds_read_b64_tr_b16 v[38:39], v5 offset:12800
    s_waitcnt lgkmcnt(12)
    v_mfma_f32_16x16x32_bf16 v[60:63], v[40:43], v[96:99], v[60:63]
    ds_read_b64_tr_b16 v[40:41], v6 offset:10240
    ds_read_b64_tr_b16 v[42:43], v6 offset:12800
    s_waitcnt lgkmcnt(12)
    v_mfma_f32_16x16x32_bf16 v[64:67], v[44:47], v[96:99], v[64:67]
    ds_read_b64_tr_b16 v[44:45], v6 offset:10272
    ds_read_b64_tr_b16 v[46:47], v6 offset:12832
    s_barrier
    s_waitcnt vmcnt(1)
    s_waitcnt lgkmcnt(12)
    v_mfma_f32_16x16x32_bf16 v[48:51], v[8:11], v[100:103], v[48:51]
    s_waitcnt lgkmcnt(12)
    v_mfma_f32_16x16x32_bf16 v[52:55], v[12:15], v[100:103], v[52:55]
    s_waitcnt lgkmcnt(12)
    v_mfma_f32_16x16x32_bf16 v[56:59], v[16:19], v[100:103], v[56:59]
    s_waitcnt lgkmcnt(12)
    v_mfma_f32_16x16x32_bf16 v[60:63], v[20:23], v[100:103], v[60:63]
    s_waitcnt lgkmcnt(10)
    v_mfma_f32_16x16x32_bf16 v[64:67], v[24:27], v[100:103], v[64:67]
    s_waitcnt vmcnt(0)
    s_waitcnt lgkmcnt(8)
    v_mfma_f32_16x16x32_bf16 v[48:51], v[28:31], v[104:107], v[48:51]
    s_waitcnt lgkmcnt(6)
    v_mfma_f32_16x16x32_bf16 v[52:55], v[32:35], v[104:107], v[52:55]
    s_waitcnt lgkmcnt(4)
    v_mfma_f32_16x16x32_bf16 v[56:59], v[36:39], v[104:107], v[56:59]
    s_waitcnt lgkmcnt(2)
    v_mfma_f32_16x16x32_bf16 v[60:63], v[40:43], v[104:107], v[60:63]
    s_waitcnt lgkmcnt(0)
    v_mfma_f32_16x16x32_bf16 v[64:67], v[44:47], v[104:107], v[64:67]
    s_nop 4
    ds_write_b128 v126, v[56:59] offset:2048
    ds_write_b128 v126, v[60:63]
    s_nop 0
    ds_write_b128 v126, v[64:67] offset:1024
    v_lshlrev_b32 v8, 16, v120
    v_and_b32 v9, 0xffff0000, v120
    v_lshlrev_b32 v10, 16, v121
    v_and_b32 v11, 0xffff0000, v121
    v_lshlrev_b32 v12, 16, v122
    v_and_b32 v13, 0xffff0000, v122
    v_lshlrev_b32 v14, 16, v123
    v_and_b32 v15, 0xffff0000, v123
    v_lshlrev_b32 v16, 16, v124
    v_and_b32 v17, 0xffff0000, v124
    v_lshlrev_b32 v18, 16, v125
    v_and_b32 v19, 0xffff0000, v125
    s_waitcnt lgkmcnt(0)
    s_barrier
    ds_read_b128 v[68:71], v127 offset:0
    ds_read_b128 v[72:75], v127 offset:1024
    ds_read_b128 v[76:79], v127 offset:2048
    s_waitcnt lgkmcnt(2)
    v_add_f32 v48, v48, v68
    v_add_f32 v49, v49, v69
    v_add_f32 v50, v50, v70
    v_add_f32 v51, v51, v71
    v_fma_f32 v48, v48, v108, v8
    v_fma_f32 v49, v49, v109, v9
    v_fma_f32 v50, v50, v110, v10
    v_fma_f32 v51, v51, v111, v11
    v_cvt_pk_bf16_f32 v48, v48, v49
    v_cvt_pk_bf16_f32 v49, v50, v51
    buffer_store_dwordx2 v[48:49], v3, s[12:15], s38 offen offset:0
    s_waitcnt lgkmcnt(1)
    v_add_f32 v52, v52, v72
    v_add_f32 v53, v53, v73
    v_add_f32 v54, v54, v74
    v_add_f32 v55, v55, v75
    v_fma_f32 v52, v52, v112, v12
    v_fma_f32 v53, v53, v113, v13
    v_fma_f32 v54, v54, v114, v14
    v_fma_f32 v55, v55, v115, v15
    v_cvt_pk_bf16_f32 v52, v52, v53
    v_cvt_pk_bf16_f32 v53, v54, v55
    buffer_store_dwordx2 v[52:53], v3, s[12:15], s38 offen offset:32
    s_cmp_lg_u32 s53, 0
    s_cbranch_scc1 k2_exit
    s_waitcnt lgkmcnt(0)
    v_add_f32 v56, v56, v76
    v_add_f32 v57, v57, v77
    v_add_f32 v58, v58, v78
    v_add_f32 v59, v59, v79
    v_fma_f32 v56, v56, v116, v16
    v_fma_f32 v57, v57, v117, v17
    v_fma_f32 v58, v58, v118, v18
    v_fma_f32 v59, v59, v119, v19
    v_cvt_pk_bf16_f32 v56, v56, v57
    v_cvt_pk_bf16_f32 v57, v58, v59
    buffer_store_dwordx2 v[56:57], v3, s[12:15], s37 offen offset:64
    s_endpgm
pj_nokey:
    s_mov_b32 s27, 0
pj_nk:
    s_sleep 2
    v_and_b32 v127, 7, v1
    v_lshlrev_b32 v127, 2, v127
    buffer_load_dword v127, v127, s[20:23], s63 offen sc1
    s_add_u32 s27, s27, 1
    s_cmp_ge_u32 s27, 0x20000
    s_waitcnt vmcnt(0)
    s_cbranch_scc1 pj_sel
    v_cmp_eq_u32 vcc, 0, v127
    s_cbranch_vccnz pj_nk
    s_branch pj_sel
pj_hit0:
    s_waitcnt vmcnt(2)
    v_readfirstlane_b32 s31, v31
    s_cmp_ge_u32 s31, 192
    s_cbranch_scc1 pj_moe_ok
    s_mov_b32 s27, 0
pj_moe:
    s_waitcnt vmcnt(0)
    v_readfirstlane_b32 s31, v31
    s_add_u32 s27, s27, 1
    s_cmp_ge_u32 s31, 192
    s_cbranch_scc1 pj_moe_ok
    s_cmp_ge_u32 s27, 0x20000
    s_cbranch_scc1 pj_moe_ok
    s_sleep 4
    global_load_dword v31, v30, s[10:11] sc1
    s_branch pj_moe
pj_moe_ok:
    s_ff1_i32_b32 s42, s41
    s_bitset0_b32 s41, s42
    v_readlane_b32 s43, v127, s42
    v_lshlrev_b32 v126, 4, v7
    s_mul_i32 s31, s42, 2560
    s_lshl_b32 s44, s50, 1
    s_add_u32 s31, s31, s44
    s_add_u32 s31, s31, 10733568
    s_lshl_b32 s44, s48, 1
    s_add_u32 s44, s44, s31
    buffer_load_dwordx4 v[56:59], v126, s[20:23], s44 offen sc1
    buffer_load_dwordx4 v[60:63], v126, s[20:23], s44 offen offset:64 sc1
    buffer_load_dwordx4 v[64:67], v126, s[20:23], s31 offen offset:128 sc1
    s_addk_i32 s31, 20480
    s_addk_i32 s44, 20480
    buffer_load_dwordx4 v[96:99], v126, s[20:23], s44 offen sc1
    buffer_load_dwordx4 v[100:103], v126, s[20:23], s44 offen offset:64 sc1
    buffer_load_dwordx4 v[104:107], v126, s[20:23], s31 offen offset:128 sc1
    s_addk_i32 s31, 20480
    s_addk_i32 s44, 20480
    buffer_load_dwordx4 v[80:83], v126, s[20:23], s44 offen sc1
    buffer_load_dwordx4 v[84:87], v126, s[20:23], s44 offen offset:64 sc1
    buffer_load_dwordx4 v[68:71], v126, s[20:23], s31 offen offset:128 sc1
    s_addk_i32 s31, 20480
    s_addk_i32 s44, 20480
    buffer_load_dwordx4 v[76:79], v126, s[20:23], s44 offen sc1
    buffer_load_dwordx4 v[88:91], v126, s[20:23], s44 offen offset:64 sc1
    buffer_load_dwordx4 v[92:95], v126, s[20:23], s31 offen offset:128 sc1
    s_bitcmp1_b32 s46, 8
    s_bitset1_b32 s46, 8
    s_cbranch_scc0 pj_ret0
pj_hit:
    s_and_b32 s31, s43, 0xffff0000
    s_ashr_i32 s44, s31, 31
    s_orn2_b32 s44, 0x80000000, s44
    s_xor_b32 s31, s31, s44
    s_and_b32 s31, s31, 0xffff0000
    v_mul_f32 v126, s31, v52
    v_exp_f32 v126, v126
    s_bfe_u32 s31, s43, 0x40003
    s_sub_u32 s31, 15, s31
    v_add_f32 v126, 1.0, v126
    v_rcp_f32 v126, v126
    v_cmp_eq_u32 s[44:45], s31, v0
    v_cvt_pk_bf16_f32 v126, v126, v126
    v_and_b32 v126, 0xffff0000, v126
    s_bitcmp1_b32 s46, 9
    s_bitset1_b32 s46, 9
    s_cbranch_scc0 pj_nw
    s_waitcnt vmcnt(0)
pj_nw:
    v_pk_add_f32 v[56:57], v[56:57], v[96:97]
    v_pk_add_f32 v[58:59], v[58:59], v[98:99]
    v_pk_add_f32 v[60:61], v[60:61], v[100:101]
    v_pk_add_f32 v[62:63], v[62:63], v[102:103]
    v_pk_add_f32 v[64:65], v[64:65], v[104:105]
    v_pk_add_f32 v[66:67], v[66:67], v[106:107]
    v_pk_add_f32 v[56:57], v[56:57], v[80:81]
    v_pk_add_f32 v[58:59], v[58:59], v[82:83]
    v_pk_add_f32 v[60:61], v[60:61], v[84:85]
    v_pk_add_f32 v[62:63], v[62:63], v[86:87]
    v_pk_add_f32 v[64:65], v[64:65], v[68:69]
    v_pk_add_f32 v[66:67], v[66:67], v[70:71]
    v_pk_add_f32 v[56:57], v[56:57], v[76:77]
    v_pk_add_f32 v[58:59], v[58:59], v[78:79]
    v_pk_add_f32 v[60:61], v[60:61], v[88:89]
    v_pk_add_f32 v[62:63], v[62:63], v[90:91]
    v_pk_add_f32 v[64:65], v[64:65], v[92:93]
    v_pk_add_f32 v[66:67], v[66:67], v[94:95]
    s_mov_b64 exec, s[44:45]
    v_fmac_f32 v108, v56, v126
    v_fmac_f32 v109, v57, v126
    v_fmac_f32 v110, v58, v126
    v_fmac_f32 v111, v59, v126
    v_fmac_f32 v112, v60, v126
    v_fmac_f32 v113, v61, v126
    v_fmac_f32 v114, v62, v126
    v_fmac_f32 v115, v63, v126
    v_fmac_f32 v116, v64, v126
    v_fmac_f32 v117, v65, v126
    v_fmac_f32 v118, v66, v126
    v_fmac_f32 v119, v67, v126
    s_mov_b64 exec, -1
    s_cmp_lg_u32 s41, 0
    s_cbranch_scc1 pj_moe_ok
    s_branch pj_gate
k2_hook:
    s_cmp_gt_u32 s27, 5
    s_cbranch_scc1 k2_late
    s_cmp_eq_u32 s27, 5
    s_cbranch_scc1 k2_sw
    buffer_load_dword v127, v126, s[12:15], s57 offen
    s_mov_b32 s58, 5
    s_branch k2_nl
k2_sw:
    v_lshlrev_b32 v2, 4, v0
    v_add_u32 v3, 10240, v2
    v_add_u32 v4, s39, v2
    s_mul_i32 s28, s61, 102400
    s_add_u32 s28, s28, 10815488
    s_movk_i32 s59, 20480
    s_branch k2_nl
k2_late:
    s_movk_i32 s58, 99
    v_and_b32 v0, 15, v1
    v_lshrrev_b32 v125, 4, v1
    v_mul_u32_u24 v126, 1280, v0
    v_lshl_add_u32 v126, v125, 3, v126
    v_lshlrev_b32 v0, 2, v0
    v_and_b32 v127, 28, v0
    buffer_load_dwordx2 v[120:121], v126, s[16:19], s38 offen
    buffer_load_dwordx2 v[122:123], v126, s[16:19], s38 offen offset:32
    buffer_load_dwordx2 v[124:125], v126, s[16:19], s37 offen offset:64
    buffer_load_dword v0, v0, s[20:23], s62 offen
    buffer_load_dword v127, v127, s[20:23], s63 offen sc1
    s_branch k2_nl
k2_slow:
    v_lshrrev_b32 v104, 5, v1
    v_and_b32 v105, 31, v1
    s_and_b32 s31, s25, 1
    s_lshl_b32 s33, s31, 8
    v_lshl_add_u32 v5, v1, 4, s33
    s_xor_b32 s31, s31, 1
    s_lshl_b32 s33, s31, 10
    v_lshl_add_u32 v7, v1, 3, s33
    v_add_u32 v5, s45, v5
    v_add_u32 v7, s45, v7
    v_lshrrev_b32 v106, 1, v105
    v_xor_b32 v106, v106, v105
    v_and_b32 v106, 4, v106
    v_mul_u32_u24 v106, 3, v106
    v_xor_b32 v105, v105, v106
    v_mul_u32_u24 v6, 10240, v104
    v_lshl_add_u32 v6, v105, 4, v6
    v_add_u32 v6, s46, v6
    v_add_u32 v4, 20480, v6
    v_mov_b32 v72, 0
    v_mov_b32 v73, 0
    v_mov_b32 v74, 0
    v_mov_b32 v75, 0
    v_mov_b32 v76, 0
    v_mov_b32 v77, 0
    v_mov_b32 v78, 0
    v_mov_b32 v79, 0
    v_mov_b32 v80, 0
    v_mov_b32 v81, 0
    v_mov_b32 v82, 0
    v_mov_b32 v83, 0
    v_mov_b32 v84, 0
    v_mov_b32 v85, 0
    v_mov_b32 v86, 0
    v_mov_b32 v87, 0
    v_mov_b32 v107, 0xff800000
    s_mov_b32 s32, 0
k2_s_pass:
    s_mov_b32 s28, 0
k2_s_loop:
    buffer_load_dwordx4 v[20:23], v5, s[20:23], s28 offen
    buffer_load_dwordx2 v[24:25], v7, s[20:23], s28 offen
    s_mov_b64 exec, s[40:41]
    buffer_load_dwordx4 v[32:35], v6, s[20:23], s28 offen
    buffer_load_dwordx4 v[36:39], v4, s[20:23], s28 offen
    s_mov_b64 exec, -1
    s_waitcnt vmcnt(0)
    v_mfma_f32_32x32x16_bf16 v[56:71], v[20:23], v[8:11], v[72:87]
    v_mfma_f32_32x32x8_bf16 v[56:71], v[24:25], v[12:13], v[56:71]
    s_nop 11
    s_cmp_eq_u32 s32, 0
    s_cbranch_scc0 k2_s_p2
    v_max3_f32 v107, v56, v57, v107
    v_max3_f32 v107, v58, v59, v107
    v_max3_f32 v107, v60, v61, v107
    v_max3_f32 v107, v62, v63, v107
    v_max3_f32 v107, v64, v65, v107
    v_max3_f32 v107, v66, v67, v107
    v_max3_f32 v107, v68, v69, v107
    v_max3_f32 v107, v70, v71, v107
    s_branch k2_s_next
k2_s_p2:
    v_exp_f32 v56, v56
    v_exp_f32 v57, v57
    v_exp_f32 v58, v58
    v_exp_f32 v59, v59
    v_exp_f32 v60, v60
    v_exp_f32 v61, v61
    v_exp_f32 v62, v62
    v_exp_f32 v63, v63
    v_exp_f32 v64, v64
    v_exp_f32 v65, v65
    v_exp_f32 v66, v66
    v_exp_f32 v67, v67
    v_exp_f32 v68, v68
    v_exp_f32 v69, v69
    v_exp_f32 v70, v70
    v_exp_f32 v71, v71
    s_nop 0
    v_cvt_pk_bf16_f32 v48, v56, v57
    v_cvt_pk_bf16_f32 v49, v58, v59
    v_cvt_pk_bf16_f32 v50, v60, v61
    v_cvt_pk_bf16_f32 v51, v62, v63
    v_cvt_pk_bf16_f32 v52, v64, v65
    v_cvt_pk_bf16_f32 v53, v66, v67
    v_cvt_pk_bf16_f32 v54, v68, v69
    v_cvt_pk_bf16_f32 v55, v70, v71
    s_nop 1
    v_mfma_f32_32x32x16_bf16 v[88:103], v[32:35], v[48:51], v[88:103]
    v_mfma_f32_32x32x16_bf16 v[88:103], v[36:39], v[52:55], v[88:103]
k2_s_next:
    s_add_u32 s28, s28, 122880
    s_cmp_lt_u32 s28, 7864320
    s_cbranch_scc1 k2_s_loop
    s_nop 11
    s_cmp_eq_u32 s32, 0
    s_cbranch_scc0 k2_fin
    v_mov_b32 v111, v107
    s_nop 1
    v_permlane32_swap_b32 v107, v111
    v_max_f32 v107, v107, v111
    v_sub_f32 v72, 0, v107
    v_sub_f32 v73, 0, v107
    v_sub_f32 v74, 0, v107
    v_sub_f32 v75, 0, v107
    v_sub_f32 v76, 0, v107
    v_sub_f32 v77, 0, v107
    v_sub_f32 v78, 0, v107
    v_sub_f32 v79, 0, v107
    v_sub_f32 v80, 0, v107
    v_sub_f32 v81, 0, v107
    v_sub_f32 v82, 0, v107
    v_sub_f32 v83, 0, v107
    v_sub_f32 v84, 0, v107
    v_sub_f32 v85, 0, v107
    v_sub_f32 v86, 0, v107
    v_sub_f32 v87, 0, v107
    v_mov_b32 v88, 0
    v_mov_b32 v89, 0
    v_mov_b32 v90, 0
    v_mov_b32 v91, 0
    v_mov_b32 v92, 0
    v_mov_b32 v93, 0
    v_mov_b32 v94, 0
    v_mov_b32 v95, 0
    v_mov_b32 v96, 0
    v_mov_b32 v97, 0
    v_mov_b32 v98, 0
    v_mov_b32 v99, 0
    v_mov_b32 v100, 0
    v_mov_b32 v101, 0
    v_mov_b32 v102, 0
    v_mov_b32 v103, 0
    s_mov_b32 s32, 1
    s_branch k2_s_pass
k2_other:
    s_setprio 3
    s_cmp_ge_u32 s2, 352
    s_cbranch_scc1 k2_exit
    s_load_dwordx4 s[4:7], s[0:1], 40
    s_load_dwordx2 s[8:9], s[0:1], 56
    s_sub_u32 s25, s2, 256
    s_and_b32 s26, s25, 7
    s_mul_i32 s26, s26, 12
    s_lshr_b32 s27, s25, 3
    s_add_u32 s26, s26, s27
    v_lshrrev_b32 v7, 4, v1
    v_and_b32 v4, 15, v1
    v_lshlrev_b32 v5, 4, v1
    s_waitcnt lgkmcnt(0)
    s_mov_b32 s20, s10
    s_mov_b32 s21, s11
    s_mov_b32 s22, 11634688
    s_mov_b32 s23, 0x20000
    s_cmp_lt_u32 s24, 4
    s_cbranch_scc1 moe_c
    s_cmp_eq_u32 s24, 7
    s_cbranch_scc1 k2_exit
    s_cmp_eq_u32 s24, 5
    s_cselect_b32 s12, s6, s4
    s_cselect_b32 s13, s7, s5
    v_lshrrev_b32 v2, 1, v1
    v_mul_u32_u24 v2, 3072, v2
    v_and_b32 v3, 1, v1
    v_lshl_add_u32 v2, v3, 4, v2
    s_lshl_b32 s28, s26, 5
    s_mov_b32 s29, 98304
    s_cmp_lg_u32 s24, 6
    s_cbranch_scc1 moe_st
    s_mov_b32 s12, s8
    s_mov_b32 s13, s9
    v_mov_b32 v2, v5
    s_mul_i32 s28, s26, 20480
    s_movk_i32 s29, 1024
moe_st:
    s_mov_b32 s14, 1966080
    s_mov_b32 s15, 0x20000
    s_sub_u32 s30, s24, 4
    s_mul_i32 s30, s30, 20480
    s_and_b32 s27, s26, 3
    s_mul_i32 s27, s27, 5
    s_mov_b32 s33, 0
    s_setprio 0
    s_barrier
moe_stl:
    s_lshl_b32 s31, s27, 10
    s_add_u32 m0, s30, s31
    s_mul_i32 s31, s27, s29
    s_add_u32 s31, s31, s28
    buffer_load_dwordx4 v2, s[12:15], s31 offen lds
    s_add_u32 s27, s27, 1
    s_cmp_eq_u32 s27, 20
    s_cselect_b32 s27, 0, s27
    s_add_u32 s33, s33, 1
    s_cmp_lt_u32 s33, 20
    s_waitcnt vmcnt(1)
    s_cbranch_scc1 moe_stl
    s_waitcnt vmcnt(0)
    s_barrier
    s_endpgm
moe_c:
    s_cmp_lg_u32 s24, 3
    s_cbranch_scc1 moe_w0
    v_lshlrev_b32 v3, 3, v1
    s_mov_b32 s31, 10502144
    buffer_load_dwordx2 v[10:11], v3, s[20:23], s31 offen
    v_mov_b32 v9, 0
    s_mov_b32 s27, 0
    s_waitcnt vmcnt(0)
moe_top:
    v_max_u32 v8, v10, v11
    s_nop 1
    v_max_u32_dpp v8, v8, v8 row_ror:8 row_mask:0xf bank_mask:0xf
    s_nop 1
    v_max_u32_dpp v8, v8, v8 row_ror:4 row_mask:0xf bank_mask:0xf
    s_nop 1
    v_max_u32_dpp v8, v8, v8 row_ror:2 row_mask:0xf bank_mask:0xf
    s_nop 1
    v_max_u32_dpp v8, v8, v8 row_ror:1 row_mask:0xf bank_mask:0xf
    s_nop 1
    v_max_u32_dpp v8, v8, v8 row_bcast:15 row_mask:0xa bank_mask:0xf
    s_nop 1
    v_max_u32_dpp v8, v8, v8 row_bcast:31 row_mask:0xc bank_mask:0xf
    s_nop 1
    v_readlane_b32 s31, v8, 63
    s_mov_b32 m0, s27
    s_add_u32 s27, s27, 1
    v_cmp_ne_u32 s[40:41], s31, v10
    v_cmp_ne_u32 s[42:43], s31, v11
    v_writelane_b32 v9, s31, m0
    s_cmp_lt_u32 s27, 8
    v_cndmask_b32 v10, 0, v10, s[40:41]
    v_cndmask_b32 v11, 0, v11, s[42:43]
    s_cbranch_scc1 moe_top
    s_cmp_ge_u32 s25, 32
    s_cbranch_scc1 moe_nk
    v_lshlrev_b32 v3, 2, v1
    s_mov_b64 exec, 0xff
    s_lshl_b32 s31, s25, 7
    s_add_u32 s31, s31, 10721280
    buffer_store_dword v9, v3, s[20:23], s31 offen sc1
    s_mov_b64 exec, -1
moe_nk:
    s_mov_b32 s27, 0
    s_mov_b32 s30, 61440
moe_xs:
    v_readlane_b32 s31, v9, s27
    s_mov_b32 m0, s30
    s_bfe_u32 s33, s31, 0x4000a
    s_sub_u32 s33, 15, s33
    s_lshl_b32 s33, s33, 3
    s_and_b32 s31, s31, 7
    s_or_b32 s33, s33, s31
    s_mul_i32 s33, s33, 1280
    s_add_u32 s33, s33, 10553344
    buffer_load_dwordx4 v5, s[20:23], s33 offen lds
    s_mov_b64 exec, 0xffff
    buffer_load_dwordx4 v5, s[20:23], s33 offen offset:1024 lds
    s_mov_b64 exec, -1
    s_addk_i32 s30, 1296
    s_add_u32 s27, s27, 1
    s_cmp_lt_u32 s27, 8
    s_cbranch_scc1 moe_xs
    s_waitcnt vmcnt(0)
    s_barrier
    s_branch moe_dn
moe_w0:
    s_barrier
    s_cmp_ge_u32 s24, 2
    s_cbranch_scc1 moe_dn
    v_lshlrev_b32 v6, 3, v4
    v_lshl_add_u32 v6, v7, 8, v6
    s_mul_i32 s31, s24, 20480
    v_add_u32 v6, s31, v6
    v_bfe_u32 v9, v1, 2, 2
    v_and_b32 v8, 1, v1
    v_lshl_add_u32 v9, v9, 1, v8
    v_mul_u32_u24 v8, 1296, v9
    v_lshl_add_u32 v8, v7, 4, v8
    v_add_u32 v8, 61440, v8
    v_add_u32 v5, 71808, v5
    s_setprio 0
    s_waitcnt vmcnt(0)
    s_barrier
    ds_read_b64_tr_b16 v[16:17], v6 offset:0
    ds_read_b64_tr_b16 v[18:19], v6 offset:128
    ds_read_b128 v[20:23], v8 offset:0
    ds_read_b64_tr_b16 v[24:25], v6 offset:1024
    ds_read_b64_tr_b16 v[26:27], v6 offset:1152
    ds_read_b128 v[28:31], v8 offset:64
    ds_read_b64_tr_b16 v[32:33], v6 offset:2048
    ds_read_b64_tr_b16 v[34:35], v6 offset:2176
    ds_read_b128 v[36:39], v8 offset:128
    ds_read_b64_tr_b16 v[40:41], v6 offset:3072
    ds_read_b64_tr_b16 v[42:43], v6 offset:3200
    ds_read_b128 v[44:47], v8 offset:192
    ds_read_b64_tr_b16 v[48:49], v6 offset:4096
    ds_read_b64_tr_b16 v[50:51], v6 offset:4224
    ds_read_b128 v[52:55], v8 offset:256
    s_waitcnt lgkmcnt(6)
    ds_read_b64_tr_b16 v[56:57], v6 offset:5120
    ds_read_b64_tr_b16 v[58:59], v6 offset:5248
    ds_read_b128 v[60:63], v8 offset:320
    ds_read_b64_tr_b16 v[64:65], v6 offset:6144
    ds_read_b64_tr_b16 v[66:67], v6 offset:6272
    ds_read_b128 v[68:71], v8 offset:384
    ds_read_b64_tr_b16 v[72:73], v6 offset:7168
    ds_read_b64_tr_b16 v[74:75], v6 offset:7296
    ds_read_b128 v[76:79], v8 offset:448
    s_waitcnt lgkmcnt(6)
    ds_read_b64_tr_b16 v[80:81], v6 offset:8192
    ds_read_b64_tr_b16 v[82:83], v6 offset:8320
    ds_read_b128 v[84:87], v8 offset:512
    ds_read_b64_tr_b16 v[88:89], v6 offset:9216
    ds_read_b64_tr_b16 v[90:91], v6 offset:9344
    ds_read_b128 v[92:95], v8 offset:576
    s_waitcnt lgkmcnt(0)
    s_setprio 3
    v_mfma_f32_16x16x32_bf16 v[12:15], v[16:19], v[20:23], 0
    v_mfma_f32_16x16x32_bf16 v[12:15], v[24:27], v[28:31], v[12:15]
    v_mfma_f32_16x16x32_bf16 v[12:15], v[32:35], v[36:39], v[12:15]
    v_mfma_f32_16x16x32_bf16 v[12:15], v[40:43], v[44:47], v[12:15]
    v_mfma_f32_16x16x32_bf16 v[12:15], v[48:51], v[52:55], v[12:15]
    v_mfma_f32_16x16x32_bf16 v[12:15], v[56:59], v[60:63], v[12:15]
    v_mfma_f32_16x16x32_bf16 v[12:15], v[64:67], v[68:71], v[12:15]
    v_mfma_f32_16x16x32_bf16 v[12:15], v[72:75], v[76:79], v[12:15]
    v_mfma_f32_16x16x32_bf16 v[12:15], v[80:83], v[84:87], v[12:15]
    v_mfma_f32_16x16x32_bf16 v[12:15], v[88:91], v[92:95], v[12:15]
    s_setprio 0
    ds_read_b64_tr_b16 v[16:17], v6 offset:10240
    ds_read_b64_tr_b16 v[18:19], v6 offset:10368
    ds_read_b128 v[20:23], v8 offset:640
    ds_read_b64_tr_b16 v[24:25], v6 offset:11264
    ds_read_b64_tr_b16 v[26:27], v6 offset:11392
    ds_read_b128 v[28:31], v8 offset:704
    ds_read_b64_tr_b16 v[32:33], v6 offset:12288
    ds_read_b64_tr_b16 v[34:35], v6 offset:12416
    ds_read_b128 v[36:39], v8 offset:768
    ds_read_b64_tr_b16 v[40:41], v6 offset:13312
    ds_read_b64_tr_b16 v[42:43], v6 offset:13440
    ds_read_b128 v[44:47], v8 offset:832
    ds_read_b64_tr_b16 v[48:49], v6 offset:14336
    ds_read_b64_tr_b16 v[50:51], v6 offset:14464
    ds_read_b128 v[52:55], v8 offset:896
    s_waitcnt lgkmcnt(6)
    ds_read_b64_tr_b16 v[56:57], v6 offset:15360
    ds_read_b64_tr_b16 v[58:59], v6 offset:15488
    ds_read_b128 v[60:63], v8 offset:960
    ds_read_b64_tr_b16 v[64:65], v6 offset:16384
    ds_read_b64_tr_b16 v[66:67], v6 offset:16512
    ds_read_b128 v[68:71], v8 offset:1024
    ds_read_b64_tr_b16 v[72:73], v6 offset:17408
    ds_read_b64_tr_b16 v[74:75], v6 offset:17536
    ds_read_b128 v[76:79], v8 offset:1088
    s_waitcnt lgkmcnt(6)
    ds_read_b64_tr_b16 v[80:81], v6 offset:18432
    ds_read_b64_tr_b16 v[82:83], v6 offset:18560
    ds_read_b128 v[84:87], v8 offset:1152
    ds_read_b64_tr_b16 v[88:89], v6 offset:19456
    ds_read_b64_tr_b16 v[90:91], v6 offset:19584
    ds_read_b128 v[92:95], v8 offset:1216
    s_waitcnt lgkmcnt(0)
    s_setprio 3
    v_mfma_f32_16x16x32_bf16 v[12:15], v[16:19], v[20:23], v[12:15]
    v_mfma_f32_16x16x32_bf16 v[12:15], v[24:27], v[28:31], v[12:15]
    v_mfma_f32_16x16x32_bf16 v[12:15], v[32:35], v[36:39], v[12:15]
    v_mfma_f32_16x16x32_bf16 v[12:15], v[40:43], v[44:47], v[12:15]
    v_mfma_f32_16x16x32_bf16 v[12:15], v[48:51], v[52:55], v[12:15]
    v_mfma_f32_16x16x32_bf16 v[12:15], v[56:59], v[60:63], v[12:15]
    v_mfma_f32_16x16x32_bf16 v[12:15], v[64:67], v[68:71], v[12:15]
    v_mfma_f32_16x16x32_bf16 v[12:15], v[72:75], v[76:79], v[12:15]
    v_mfma_f32_16x16x32_bf16 v[12:15], v[80:83], v[84:87], v[12:15]
    v_mfma_f32_16x16x32_bf16 v[12:15], v[88:91], v[92:95], v[12:15]
    s_cmp_eq_u32 s24, 0
    s_nop 6
    s_cbranch_scc1 moe_g
    ds_write_b128 v5, v[12:15]
    s_waitcnt lgkmcnt(0)
    s_barrier
    s_endpgm
moe_g:
    v_mul_f32 v16, 0xbfb8aa3b, v12
    v_mul_f32 v17, 0xbfb8aa3b, v13
    v_mul_f32 v18, 0xbfb8aa3b, v14
    v_mul_f32 v19, 0xbfb8aa3b, v15
    v_exp_f32 v16, v16
    v_exp_f32 v17, v17
    v_exp_f32 v18, v18
    v_exp_f32 v19, v19
    v_add_f32 v16, 1.0, v16
    v_add_f32 v17, 1.0, v17
    v_add_f32 v18, 1.0, v18
    v_add_f32 v19, 1.0, v19
    v_rcp_f32 v16, v16
    v_rcp_f32 v17, v17
    v_rcp_f32 v18, v18
    v_rcp_f32 v19, v19
    s_barrier
    ds_read_b128 v[20:23], v5
    v_mul_f32 v12, v12, v16
    v_mul_f32 v13, v13, v17
    v_mul_f32 v14, v14, v18
    v_mul_f32 v15, v15, v19
    v_lshlrev_b32 v5, 3, v1
    s_waitcnt lgkmcnt(0)
    v_mul_f32 v12, v12, v20
    v_mul_f32 v13, v13, v21
    v_mul_f32 v14, v14, v22
    v_mul_f32 v15, v15, v23
    v_add_u32 v5, 72832, v5
    v_cvt_pk_bf16_f32 v12, v12, v13
    v_cvt_pk_bf16_f32 v13, v14, v15
    ds_write_b64 v5, v[12:13]
    s_waitcnt lgkmcnt(0)
    s_barrier
    s_endpgm
moe_dn:
    v_lshrrev_b32 v6, 2, v1
    v_mul_u32_u24 v6, 1280, v6
    v_and_b32 v8, 3, v1
    v_lshl_add_u32 v6, v8, 3, v6
    s_sub_u32 s27, s24, 2
    s_mul_i32 s31, s27, 640
    s_add_u32 s31, s31, 40960
    v_add_u32 v6, s31, v6
    v_mul_u32_u24 v10, 5120, v7
    v_lshl_add_u32 v10, v4, 2, v10
    s_mul_i32 s34, s27, 1280
    s_and_b32 s31, s26, 3
    s_mul_i32 s31, s31, 20480
    s_add_u32 s34, s34, s31
    s_add_u32 s34, s34, 10733568
    v_lshlrev_b32 v5, 3, v1
    v_add_u32 v5, 72832, v5
    s_setprio 0
    s_waitcnt vmcnt(0)
    s_barrier
    ds_read_b64_tr_b16 v[16:17], v6 offset:0
    ds_read_b64_tr_b16 v[18:19], v6 offset:32
    ds_read_b64_tr_b16 v[20:21], v6 offset:64
    ds_read_b64_tr_b16 v[22:23], v6 offset:96
    ds_read_b64_tr_b16 v[24:25], v6 offset:128
    ds_read_b64_tr_b16 v[26:27], v6 offset:160
    ds_read_b64_tr_b16 v[28:29], v6 offset:192
    ds_read_b64_tr_b16 v[30:31], v6 offset:224
    ds_read_b64_tr_b16 v[32:33], v6 offset:256
    ds_read_b64_tr_b16 v[34:35], v6 offset:288
    ds_read_b64_tr_b16 v[36:37], v6 offset:320
    ds_read_b64_tr_b16 v[38:39], v6 offset:352
    ds_read_b64_tr_b16 v[40:41], v6 offset:384
    ds_read_b64_tr_b16 v[42:43], v6 offset:416
    s_waitcnt lgkmcnt(4)
    ds_read_b64_tr_b16 v[44:45], v6 offset:448
    ds_read_b64_tr_b16 v[46:47], v6 offset:480
    ds_read_b64_tr_b16 v[48:49], v6 offset:512
    ds_read_b64_tr_b16 v[50:51], v6 offset:544
    ds_read_b64_tr_b16 v[52:53], v6 offset:576
    ds_read_b64_tr_b16 v[54:55], v6 offset:608
    s_barrier
    s_barrier
    ds_read_b64 v[12:13], v5
    s_waitcnt lgkmcnt(0)
    s_setprio 3
    v_mfma_f32_16x16x16_bf16 v[56:59], v[12:13], v[16:17], 0
    v_mfma_f32_16x16x16_bf16 v[60:63], v[12:13], v[18:19], 0
    v_mfma_f32_16x16x16_bf16 v[64:67], v[12:13], v[20:21], 0
    v_mfma_f32_16x16x16_bf16 v[68:71], v[12:13], v[22:23], 0
    v_mfma_f32_16x16x16_bf16 v[72:75], v[12:13], v[24:25], 0
    v_mfma_f32_16x16x16_bf16 v[76:79], v[12:13], v[26:27], 0
    v_mfma_f32_16x16x16_bf16 v[80:83], v[12:13], v[28:29], 0
    v_mfma_f32_16x16x16_bf16 v[84:87], v[12:13], v[30:31], 0
    v_mfma_f32_16x16x16_bf16 v[88:91], v[12:13], v[32:33], 0
    v_mfma_f32_16x16x16_bf16 v[92:95], v[12:13], v[34:35], 0
    v_mfma_f32_16x16x16_bf16 v[96:99], v[12:13], v[36:37], 0
    v_mfma_f32_16x16x16_bf16 v[100:103], v[12:13], v[38:39], 0
    v_mfma_f32_16x16x16_bf16 v[104:107], v[12:13], v[40:41], 0
    v_mfma_f32_16x16x16_bf16 v[108:111], v[12:13], v[42:43], 0
    v_mfma_f32_16x16x16_bf16 v[112:115], v[12:13], v[44:45], 0
    v_mfma_f32_16x16x16_bf16 v[116:119], v[12:13], v[46:47], 0
    v_mfma_f32_16x16x16_bf16 v[120:123], v[12:13], v[48:49], 0
    v_mfma_f32_16x16x16_bf16 v[124:127], v[12:13], v[50:51], 0
    v_mfma_f32_16x16x16_bf16 v[16:19], v[12:13], v[52:53], 0
    v_mfma_f32_16x16x16_bf16 v[20:23], v[12:13], v[54:55], 0
    s_setprio 0
    buffer_atomic_add_f32 v56, v10, s[20:23], s34 offen offset:0
    buffer_atomic_add_f32 v57, v10, s[20:23], s34 offen offset:2560
    buffer_atomic_add_f32 v60, v10, s[20:23], s34 offen offset:64
    buffer_atomic_add_f32 v61, v10, s[20:23], s34 offen offset:2624
    buffer_atomic_add_f32 v64, v10, s[20:23], s34 offen offset:128
    buffer_atomic_add_f32 v65, v10, s[20:23], s34 offen offset:2688
    buffer_atomic_add_f32 v68, v10, s[20:23], s34 offen offset:192
    buffer_atomic_add_f32 v69, v10, s[20:23], s34 offen offset:2752
    buffer_atomic_add_f32 v72, v10, s[20:23], s34 offen offset:256
    buffer_atomic_add_f32 v73, v10, s[20:23], s34 offen offset:2816
    s_waitcnt vmcnt(8)
    buffer_atomic_add_f32 v76, v10, s[20:23], s34 offen offset:320
    buffer_atomic_add_f32 v77, v10, s[20:23], s34 offen offset:2880
    s_waitcnt vmcnt(8)
    buffer_atomic_add_f32 v80, v10, s[20:23], s34 offen offset:384
    buffer_atomic_add_f32 v81, v10, s[20:23], s34 offen offset:2944
    s_waitcnt vmcnt(8)
    buffer_atomic_add_f32 v84, v10, s[20:23], s34 offen offset:448
    buffer_atomic_add_f32 v85, v10, s[20:23], s34 offen offset:3008
    s_waitcnt vmcnt(8)
    buffer_atomic_add_f32 v88, v10, s[20:23], s34 offen offset:512
    buffer_atomic_add_f32 v89, v10, s[20:23], s34 offen offset:3072
    s_waitcnt vmcnt(8)
    buffer_atomic_add_f32 v92, v10, s[20:23], s34 offen offset:576
    buffer_atomic_add_f32 v93, v10, s[20:23], s34 offen offset:3136
    s_waitcnt vmcnt(8)
    buffer_atomic_add_f32 v96, v10, s[20:23], s34 offen offset:640
    buffer_atomic_add_f32 v97, v10, s[20:23], s34 offen offset:3200
    s_waitcnt vmcnt(8)
    buffer_atomic_add_f32 v100, v10, s[20:23], s34 offen offset:704
    buffer_atomic_add_f32 v101, v10, s[20:23], s34 offen offset:3264
    s_waitcnt vmcnt(8)
    buffer_atomic_add_f32 v104, v10, s[20:23], s34 offen offset:768
    buffer_atomic_add_f32 v105, v10, s[20:23], s34 offen offset:3328
    s_waitcnt vmcnt(8)
    buffer_atomic_add_f32 v108, v10, s[20:23], s34 offen offset:832
    buffer_atomic_add_f32 v109, v10, s[20:23], s34 offen offset:3392
    s_waitcnt vmcnt(8)
    buffer_atomic_add_f32 v112, v10, s[20:23], s34 offen offset:896
    buffer_atomic_add_f32 v113, v10, s[20:23], s34 offen offset:3456
    s_waitcnt vmcnt(8)
    buffer_atomic_add_f32 v116, v10, s[20:23], s34 offen offset:960
    buffer_atomic_add_f32 v117, v10, s[20:23], s34 offen offset:3520
    s_waitcnt vmcnt(8)
    buffer_atomic_add_f32 v120, v10, s[20:23], s34 offen offset:1024
    buffer_atomic_add_f32 v121, v10, s[20:23], s34 offen offset:3584
    s_waitcnt vmcnt(8)
    buffer_atomic_add_f32 v124, v10, s[20:23], s34 offen offset:1088
    buffer_atomic_add_f32 v125, v10, s[20:23], s34 offen offset:3648
    s_waitcnt vmcnt(8)
    buffer_atomic_add_f32 v16, v10, s[20:23], s34 offen offset:1152
    buffer_atomic_add_f32 v17, v10, s[20:23], s34 offen offset:3712
    s_waitcnt vmcnt(8)
    buffer_atomic_add_f32 v20, v10, s[20:23], s34 offen offset:1216
    buffer_atomic_add_f32 v21, v10, s[20:23], s34 offen offset:3776
    v_mov_b32 v2, 10725376
    v_mov_b32 v3, 1
    s_mov_b64 exec, 1
    s_waitcnt vmcnt(0)
    global_atomic_add v2, v3, s[10:11]
k2_exit:
    s_endpgm
code_end:
    s_endpgm
.section .rodata,"a"
.p2align 6
.amdhsa_kernel qkv_kernel
  .amdhsa_next_free_vgpr 160
  .amdhsa_next_free_sgpr 64
  .amdhsa_accum_offset 160
  .amdhsa_group_segment_fixed_size 0
  .amdhsa_kernarg_size 88
  .amdhsa_user_sgpr_count 2
  .amdhsa_user_sgpr_kernarg_segment_ptr 1
  .amdhsa_system_sgpr_workgroup_id_x 1
.end_amdhsa_kernel
.p2align 6
.amdhsa_kernel attn_kernel
  .amdhsa_next_free_vgpr 128
  .amdhsa_next_free_sgpr 80
  .amdhsa_accum_offset 128
  .amdhsa_group_segment_fixed_size 0
  .amdhsa_kernarg_size 88
  .amdhsa_user_sgpr_count 2
  .amdhsa_user_sgpr_kernarg_segment_ptr 1
  .amdhsa_system_sgpr_workgroup_id_x 1
.end_amdhsa_kernel
```
